```python
import torch

def _softmax(x, axis=-1):
    return torch.softmax(x, dim=axis)
def _gelu(x):
    return torch.nn.functional.gelu(x, approximate="tanh")
def _silu(x):
    return torch.nn.functional.silu(x)
def _sigmoid(x):
    return torch.sigmoid(x)
def _layernorm(x, axis=-1, eps=1e-5):
    m = x.mean(dim=axis, keepdim=True)
    v = x.var(dim=axis, keepdim=True, unbiased=False)
    return (x - m) / torch.sqrt(v + eps)
def _scatter_add(tgt, idx, src, axis=0):
    return tgt.clone().index_add_(axis, idx, src)
def _segment_sum(src, seg, n):
    out = torch.zeros((n,) + src.shape[1:], dtype=src.dtype)
    return out.index_add_(0, seg, src)
def _pad(x, pw):
    flat = tuple(v for pair in reversed(pw) for v in pair)
    return torch.nn.functional.pad(x, flat)

kernel_name = 'recurrent_scan__ssm_conv_h3__glu_gated_reglu__prompt'

def setup_inputs():

    _w = (lambda a: (lambda t: t.to(torch.bfloat16) if t.is_floating_point() else t)(torch.as_tensor(a)))
    def _A_setup():
        B, S, D = 1, 2048, 448
        ks = 4
        return {
            "q": _w((lambda *s: torch.randn(*s, dtype=torch.bfloat16) * 0.05)(B, S, D)),
            "k": _w((lambda *s: torch.randn(*s, dtype=torch.bfloat16) * 0.8)(B, S, D)),
            "v": _w((lambda *s: torch.randn(*s, dtype=torch.bfloat16) * 0.8)(B, S, D)),
            "shift_k": _w((lambda *s: torch.randn(*s, dtype=torch.bfloat16) * 0.8)(D, ks) * 0.5),
            "ssm_k": _w((lambda *s: torch.randn(*s, dtype=torch.bfloat16) * 0.8)(D, S) * (1.0 / S ** 0.5)),
            "ssm_D": _w((lambda *s: torch.randn(*s, dtype=torch.bfloat16) * 0.8)(D)),
        }
    _A_in = _A_setup()

    def _B_setup():
        B, S, D, F = 1, 2048, 448, 1792
        return {
            "x": _w((lambda *s: torch.randn(*s, dtype=torch.bfloat16) * 0.05)(B, S, D)),
            "W_gate": _w((lambda *s: torch.randn(*s, dtype=torch.bfloat16) * 0.2)(D, F) * (2.0 / D) ** 0.5),
            "W_up": _w((lambda *s: torch.randn(*s, dtype=torch.bfloat16) * 0.2)(D, F) * (2.0 / D) ** 0.5),
            "W_down": _w((lambda *s: torch.randn(*s, dtype=torch.bfloat16) * 0.2)(F, D) * (1.0 / F) ** 0.5),
        }
    _B_in = _B_setup()

    return {
        "A_q": _A_in["q"],
        "A_k": _A_in["k"],
        "A_v": _A_in["v"],
        "A_shift_k": _A_in["shift_k"],
        "A_ssm_k": _A_in["ssm_k"],
        "A_ssm_D": _A_in["ssm_D"],
        "B_x": _B_in["x"],
        "B_W_gate": _B_in["W_gate"],
        "B_W_up": _B_in["W_up"],
        "B_W_down": _B_in["W_down"],
    }

def reference(A_q, A_k, A_v, A_shift_k, A_ssm_k, A_ssm_D, B_x, B_W_gate, B_W_up, B_W_down):
    def _A_ref(q, k, v, shift_k, ssm_k, ssm_D):
        B, S, D = q.shape
        ks = shift_k.shape[-1]
        k_pad = _pad(k, ((0, 0), (ks - 1, 0), (0, 0)))
        k_shift = torch.zeros_like(k)
        for t in range(ks):
            k_shift = k_shift + k_pad[:, t:t + S, :] * shift_k[:, ks - 1 - t][None, None, :]
        kv = k_shift * v
        L = 2 * S
        kv_pad = _pad(kv, ((0, 0), (0, S), (0, 0)))
        kf_pad = _pad(ssm_k, ((0, 0), (0, S)))
        kv_f = (lambda x, axes=(-2,-1): torch.fft.rfft2(x.float(), dim=axes))(kv_pad[:, None, :, :], axes=(1, 2))
        kf_f = (lambda x, axes=(-2,-1): torch.fft.rfft2(x.float(), dim=axes))(kf_pad[:, None, :], axes=(1, 2))
        kf_f = (lambda x, *d: x.permute(*d))(kf_f, 1, 2, 0)
        y_f = kv_f * kf_f[None, :, :, :]
        y = (lambda x, s, axes=(-2,-1): torch.fft.irfft2(x, s=s, dim=axes).to(torch.bfloat16))(y_f, (1, L), axes=(1, 2))[:, 0, :S, :]
        y = y + kv * ssm_D[None, None, :]
        return q * y

    def _B_ref(x, W_gate, W_up, W_down):
        gate = torch.einsum("bsd,df->bsf", x, W_gate)
        up = torch.einsum("bsd,df->bsf", x, W_up)
        gate = gate * (lambda x, dt: x.to(dt))(gate > 0, gate.dtype)
        h = gate * up
        return torch.einsum("bsf,fd->bsd", h, W_down)

    x = A_q
    xn = _layernorm(x, axis=-1)
    s = _A_ref(xn, A_k, A_v, A_shift_k, A_ssm_k, A_ssm_D)
    g = _silu(_B_ref(xn, B_W_gate, B_W_up, B_W_down))
    return x + s * g
```

```asm
; @launch grid=(256,1,1) block=(768,1,1) lds=153664
.amdgcn_target "amdgcn-amd-amdhsa--gfx950"
.text
.globl recurrent_scan__ssm_conv_h3__glu_gated_reglu__prompt_kernel
.p2align 8
.type recurrent_scan__ssm_conv_h3__glu_gated_reglu__prompt_kernel,@function
recurrent_scan__ssm_conv_h3__glu_gated_reglu__prompt_kernel:
    s_cmp_ge_u32 s2, 256
    s_cbranch_scc1 k_end
    s_load_dwordx8 s[4:11], s[0:1], 0
    s_load_dwordx4 s[12:15], s[0:1], 32
    s_load_dwordx8 s[16:23], s[0:1], 56
    s_load_dwordx4 s[24:27], s[0:1], 88
    v_and_b32 v1, 63, v0
    v_lshrrev_b32 v2, 6, v0
    s_nop 0
    v_readfirstlane_b32 s32, v2
    s_cmp_ge_u32 s2, 224
    s_cbranch_scc1 k_prep
    s_and_b32 s50, s2, 7
    s_lshr_b32 s51, s2, 3
    s_mul_i32 s33, s51, 37
    s_lshr_b32 s33, s33, 8
    s_mul_i32 s34, s33, 7
    s_sub_u32 s53, s51, s34
    s_and_b32 s34, s50, 4
    s_add_u32 s48, s34, s33
    s_and_b32 s34, s50, 3
    s_mul_i32 s34, s34, 7
    s_add_u32 s49, s34, s53
    s_lshl_b32 s34, s50, 2
    s_add_u32 s52, s34, s33
    s_cmp_ge_u32 s32, 8
    s_cbranch_scc1 k_helper
    s_lshr_b32 s54, s32, 1
    s_and_b32 s55, s32, 1
    v_and_b32 v2, 31, v1
    v_lshrrev_b32 v3, 5, v1
    v_bfe_u32 v4, v1, 2, 2
    v_xor_b32 v4, v3, v4
    s_lshl_b32 s33, s32, 5
    v_add_u32 v5, s33, v2
    v_lshlrev_b32 v5, 6, v5
    v_lshl_add_u32 v10, v4, 4, v5
    v_xor_b32 v11, 0x800, v10
    v_xor_b32 v12, 32, v10
    v_xor_b32 v13, 32, v11
    v_bfe_u32 v4, v1, 4, 1
    v_bfe_u32 v5, v1, 2, 2
    v_bfe_u32 v6, v1, 3, 1
    v_lshl_or_b32 v6, v4, 1, v6
    s_lshl_b32 s33, s55, 1
    v_xor_b32 v6, s33, v6
    v_lshl_add_u32 v7, v3, 3, v5
    v_lshlrev_b32 v7, 7, v7
    v_lshl_add_u32 v7, v4, 12, v7
    v_lshl_add_u32 v7, v6, 5, v7
    v_and_b32 v8, 3, v1
    v_lshl_add_u32 v7, v8, 3, v7
    v_add_u32 v14, 0x4000, v7
    v_xor_b32 v15, 32, v14
    v_add_u32 v16, 49152, v10
    v_add_u32 v17, 49152, v11
    v_add_u32 v18, 49152, v12
    v_add_u32 v19, 49152, v13
    v_add_u32 v20, 49152, v14
    v_add_u32 v21, 49152, v15
    v_mov_b32 v28, 0
    v_mov_b32 v29, 0
    v_mov_b32 v22, 0
    v_and_b32 v24, 15, v1
    v_lshlrev_b32 v24, 2, v24
    s_mov_b32 s94, 0
    s_waitcnt lgkmcnt(0)
    s_mov_b32 s28, s26
    s_and_b32 s29, s27, 0xffff
    s_mov_b32 s30, 16777216
    s_mov_b32 s31, 0x00020000
    s_lshl_b32 s56, s48, 9
    s_lshl_b32 s33, s49, 2
    s_add_u32 s56, s56, s33
    s_add_u32 s56, s56, 9240576
    s_lshl_b32 s57, s2, 9
    s_add_u32 s57, s57, 9240576
    s_cmp_eq_u32 s32, 7
    s_cbranch_scc1 k_init
    s_mov_b32 s36, s4
    s_and_b32 s37, s5, 0xffff
    s_mov_b32 s38, 1835008
    s_mov_b32 s39, 0x00020000
    s_mov_b32 s40, s16
    s_and_b32 s41, s17, 0xffff
    s_mov_b32 s42, 1605632
    s_mov_b32 s43, 0x00020000
    s_mov_b32 s44, s18
    s_and_b32 s45, s19, 0xffff
    s_mov_b32 s46, 1605632
    s_mov_b32 s47, 0x00020000
    s_lshr_b32 s33, s50, 2
    s_lshl_b32 s33, s33, 10
    s_mul_i32 s34, s51, 37
    s_add_u32 s33, s33, s34
    s_mul_i32 s33, s33, 896
    s_lshl_b32 s34, s32, 7
    s_add_u32 s33, s33, s34
    v_mul_u32_u24 v2, 896, v1
    s_lshl_b32 s34, s51, 4
    v_add_u32 v3, s34, v1
    v_mul_u32_u24 v4, 0x2493, v3
    v_lshrrev_b32 v4, 16, v4
    v_mul_u32_u24 v5, 7, v4
    v_sub_u32 v5, v3, v5
    v_mul_u32_u24 v4, 3584, v4
    v_lshl_add_u32 v4, v5, 7, v4
    s_and_b32 s34, s50, 3
    s_mul_i32 s34, s34, 896
    s_mul_i32 s35, s32, 229376
    s_add_u32 s34, s34, s35
    s_mov_b32 exec_hi, 31
    buffer_load_dword v6, v2, s[36:39], s33 offen
    s_mov_b64 exec, 0xffff
    buffer_load_dword v7, v4, s[40:43], s34 offen
    buffer_load_dword v8, v4, s[44:47], s34 offen
    s_mov_b64 exec, -1
    s_branch k_main
k_init:
    v_mov_b32 v2, 0
    v_lshl_add_u32 v3, v1, 2, 0
    v_add_u32 v3, 153600, v3
    s_mov_b64 exec, 0xff
    ds_write_b32 v3, v2
    s_waitcnt lgkmcnt(0)
    s_mov_b64 exec, -1
    global_load_dword v23, v22, s[24:25] sc1
k_main:
    s_cmp_ge_u32 s49, 16
    s_cbranch_scc1 k_nostat
    s_mov_b32 s36, s4
    s_and_b32 s37, s5, 0xffff
    s_mov_b32 s38, 1835008
    s_mov_b32 s39, 0x00020000
    s_lshl_b32 s33, s48, 8
    s_lshl_b32 s34, s49, 4
    s_add_u32 s33, s33, s34
    s_lshl_b32 s34, s32, 1
    s_add_u32 s33, s33, s34
    v_lshrrev_b32 v2, 5, v1
    v_add_u32 v2, s33, v2
    s_movk_i32 s34, 896
    v_mul_lo_u32 v3, v2, s34
    v_and_b32 v4, 31, v1
    v_lshl_add_u32 v3, v4, 4, v3
    v_mov_b32 v36, 0
    v_mov_b32 v37, 0
    v_mov_b32 v38, 0
    v_mov_b32 v39, 0
    buffer_load_dwordx4 v[32:35], v3, s[36:39], 0 offen
    s_mov_b32 exec_lo, 0xffffff
    s_mov_b32 exec_hi, 0xffffff
    buffer_load_dwordx4 v[36:39], v3, s[36:39], 0 offen offset:512
    s_mov_b64 exec, -1
    v_mov_b32 v40, 0
    v_mov_b32 v41, 0
    v_mov_b32 v42, 0
    v_mov_b32 v43, 0
    v_lshlrev_b32 v2, 3, v2
    s_waitcnt vmcnt(0)
    v_lshlrev_b32 v44, 16, v32
    v_and_b32 v45, 0xffff0000, v32
    v_add_f32 v40, v40, v44
    v_add_f32 v41, v41, v45
    v_fmac_f32 v42, v44, v44
    v_fmac_f32 v43, v45, v45
    v_lshlrev_b32 v46, 16, v33
    v_and_b32 v47, 0xffff0000, v33
    v_add_f32 v40, v40, v46
    v_add_f32 v41, v41, v47
    v_fmac_f32 v42, v46, v46
    v_fmac_f32 v43, v47, v47
    v_lshlrev_b32 v44, 16, v34
    v_and_b32 v45, 0xffff0000, v34
    v_add_f32 v40, v40, v44
    v_add_f32 v41, v41, v45
    v_fmac_f32 v42, v44, v44
    v_fmac_f32 v43, v45, v45
    v_lshlrev_b32 v46, 16, v35
    v_and_b32 v47, 0xffff0000, v35
    v_add_f32 v40, v40, v46
    v_add_f32 v41, v41, v47
    v_fmac_f32 v42, v46, v46
    v_fmac_f32 v43, v47, v47
    v_lshlrev_b32 v44, 16, v36
    v_and_b32 v45, 0xffff0000, v36
    v_add_f32 v40, v40, v44
    v_add_f32 v41, v41, v45
    v_fmac_f32 v42, v44, v44
    v_fmac_f32 v43, v45, v45
    v_lshlrev_b32 v46, 16, v37
    v_and_b32 v47, 0xffff0000, v37
    v_add_f32 v40, v40, v46
    v_add_f32 v41, v41, v47
    v_fmac_f32 v42, v46, v46
    v_fmac_f32 v43, v47, v47
    v_lshlrev_b32 v44, 16, v38
    v_and_b32 v45, 0xffff0000, v38
    v_add_f32 v40, v40, v44
    v_add_f32 v41, v41, v45
    v_fmac_f32 v42, v44, v44
    v_fmac_f32 v43, v45, v45
    v_lshlrev_b32 v46, 16, v39
    v_and_b32 v47, 0xffff0000, v39
    v_add_f32 v40, v40, v46
    v_add_f32 v41, v41, v47
    v_fmac_f32 v42, v46, v46
    v_fmac_f32 v43, v47, v47
    v_add_f32 v40, v40, v41
    v_add_f32 v42, v42, v43
    s_nop 1
    v_add_f32_dpp v40, v40, v40 quad_perm:[1,0,3,2] row_mask:0xf bank_mask:0xf
    v_add_f32_dpp v42, v42, v42 quad_perm:[1,0,3,2] row_mask:0xf bank_mask:0xf
    s_nop 1
    v_add_f32_dpp v40, v40, v40 quad_perm:[2,3,0,1] row_mask:0xf bank_mask:0xf
    v_add_f32_dpp v42, v42, v42 quad_perm:[2,3,0,1] row_mask:0xf bank_mask:0xf
    s_nop 1
    v_add_f32_dpp v40, v40, v40 row_ror:4 row_mask:0xf bank_mask:0xf
    v_add_f32_dpp v42, v42, v42 row_ror:4 row_mask:0xf bank_mask:0xf
    s_nop 1
    v_add_f32_dpp v40, v40, v40 row_ror:8 row_mask:0xf bank_mask:0xf
    v_add_f32_dpp v42, v42, v42 row_ror:8 row_mask:0xf bank_mask:0xf
    v_mov_b32 v41, v40
    v_mov_b32 v43, v42
    s_nop 1
    v_permlane16_swap_b32 v40, v41
    v_permlane16_swap_b32 v42, v43
    s_nop 1
    v_add_f32 v40, v40, v41
    v_add_f32 v42, v42, v43
    v_mul_f32 v40, 0x3b124925, v40
    v_mul_f32 v42, 0x3b124925, v42
    v_fma_f32 v42, -v40, v40, v42
    v_max_f32 v42, 0, v42
    v_cvt_pk_bf16_f32 v44, v40, v40
    v_lshlrev_b32 v44, 16, v44
    v_cvt_pk_bf16_f32 v42, v42, v42
    v_lshlrev_b32 v42, 16, v42
    v_add_f32 v42, 0x3727c5ac, v42
    v_cvt_pk_bf16_f32 v42, v42, v42
    v_lshlrev_b32 v42, 16, v42
    v_sqrt_f32 v42, v42
    s_nop 0
    v_cvt_pk_bf16_f32 v45, v42, v42
    v_lshlrev_b32 v45, 16, v45
    s_mov_b32 s33, 9175040
    s_mov_b32 exec_lo, 1
    s_mov_b32 exec_hi, 1
    buffer_store_dwordx2 v[44:45], v2, s[28:31], s33 offen sc1
    s_mov_b64 exec, -1
k_nostat:
    s_mov_b32 s40, s20
    s_and_b32 s41, s21, 0xffff
    s_mov_b32 s42, 1605632
    s_mov_b32 s43, 0x00020000
    v_lshrrev_b32 v2, 3, v1
    v_mul_u32_u24 v2, 896, v2
    v_bfe_u32 v3, v1, 4, 1
    v_lshlrev_b32 v3, 2, v3
    v_and_b32 v4, 7, v1
    v_xor_b32 v3, v3, v4
    v_lshl_add_u32 v2, v3, 4, v2
    s_lshl_b32 s33, s53, 7
    v_add_u32 v9, s33, v2
    s_xor_b32 s95, s32, 4
    s_mul_i32 s95, s95, 12288
    s_mul_i32 s51, s32, 200704
    s_barrier
    ds_read_b128 v[32:35], v10 offset:0
    ds_read_b64_tr_b16 v[40:41], v14 offset:0
    ds_read_b64_tr_b16 v[42:43], v14 offset:512
    ds_read_b64_tr_b16 v[44:45], v15 offset:0
    ds_read_b64_tr_b16 v[46:47], v15 offset:512
    ds_read_b128 v[36:39], v11 offset:0
    ds_read_b128 v[48:51], v12 offset:0
    ds_read_b64_tr_b16 v[56:57], v14 offset:2048
    ds_read_b64_tr_b16 v[58:59], v14 offset:2560
    ds_read_b64_tr_b16 v[60:61], v15 offset:2048
    ds_read_b64_tr_b16 v[62:63], v15 offset:2560
    ds_read_b128 v[52:55], v13 offset:0
    s_waitcnt lgkmcnt(6)
    v_mfma_f32_32x32x16_bf16 v[64:79], v[40:43], v[32:35], 0
    v_mfma_f32_32x32x16_bf16 v[96:111], v[44:47], v[32:35], 0
    v_mfma_f32_32x32x16_bf16 v[80:95], v[40:43], v[36:39], 0
    v_mfma_f32_32x32x16_bf16 v[112:127], v[44:47], v[36:39], 0
    s_waitcnt lgkmcnt(0)
    s_barrier
    ds_read_b128 v[32:35], v10 offset:24576
    ds_read_b64_tr_b16 v[40:41], v14 offset:24576
    ds_read_b64_tr_b16 v[42:43], v14 offset:25088
    ds_read_b64_tr_b16 v[44:45], v15 offset:24576
    ds_read_b64_tr_b16 v[46:47], v15 offset:25088
    ds_read_b128 v[36:39], v11 offset:24576
    v_mfma_f32_32x32x16_bf16 v[64:79], v[56:59], v[48:51], v[64:79]
    v_mfma_f32_32x32x16_bf16 v[96:111], v[60:63], v[48:51], v[96:111]
    v_mfma_f32_32x32x16_bf16 v[80:95], v[56:59], v[52:55], v[80:95]
    v_mfma_f32_32x32x16_bf16 v[112:127], v[60:63], v[52:55], v[112:127]
    ds_read_b128 v[48:51], v12 offset:24576
    ds_read_b64_tr_b16 v[56:57], v14 offset:26624
    ds_read_b64_tr_b16 v[58:59], v14 offset:27136
    ds_read_b64_tr_b16 v[60:61], v15 offset:26624
    ds_read_b64_tr_b16 v[62:63], v15 offset:27136
    ds_read_b128 v[52:55], v13 offset:24576
    s_waitcnt lgkmcnt(6)
    v_mfma_f32_32x32x16_bf16 v[64:79], v[40:43], v[32:35], v[64:79]
    v_mfma_f32_32x32x16_bf16 v[96:111], v[44:47], v[32:35], v[96:111]
    v_mfma_f32_32x32x16_bf16 v[80:95], v[40:43], v[36:39], v[80:95]
    v_mfma_f32_32x32x16_bf16 v[112:127], v[44:47], v[36:39], v[112:127]
    s_waitcnt lgkmcnt(0)
    s_barrier
    ds_read_b128 v[32:35], v16 offset:0
    ds_read_b64_tr_b16 v[40:41], v20 offset:0
    ds_read_b64_tr_b16 v[42:43], v20 offset:512
    ds_read_b64_tr_b16 v[44:45], v21 offset:0
    ds_read_b64_tr_b16 v[46:47], v21 offset:512
    ds_read_b128 v[36:39], v17 offset:0
    v_mfma_f32_32x32x16_bf16 v[64:79], v[56:59], v[48:51], v[64:79]
    v_mfma_f32_32x32x16_bf16 v[96:111], v[60:63], v[48:51], v[96:111]
    v_mfma_f32_32x32x16_bf16 v[80:95], v[56:59], v[52:55], v[80:95]
    v_mfma_f32_32x32x16_bf16 v[112:127], v[60:63], v[52:55], v[112:127]
    ds_read_b128 v[48:51], v18 offset:0
    ds_read_b64_tr_b16 v[56:57], v20 offset:2048
    ds_read_b64_tr_b16 v[58:59], v20 offset:2560
    ds_read_b64_tr_b16 v[60:61], v21 offset:2048
    ds_read_b64_tr_b16 v[62:63], v21 offset:2560
    ds_read_b128 v[52:55], v19 offset:0
    s_waitcnt lgkmcnt(6)
    v_mfma_f32_32x32x16_bf16 v[64:79], v[40:43], v[32:35], v[64:79]
    v_mfma_f32_32x32x16_bf16 v[96:111], v[44:47], v[32:35], v[96:111]
    v_mfma_f32_32x32x16_bf16 v[80:95], v[40:43], v[36:39], v[80:95]
    v_mfma_f32_32x32x16_bf16 v[112:127], v[44:47], v[36:39], v[112:127]
    s_waitcnt lgkmcnt(0)
    s_barrier
    ds_read_b128 v[32:35], v16 offset:24576
    ds_read_b64_tr_b16 v[40:41], v20 offset:24576
    ds_read_b64_tr_b16 v[42:43], v20 offset:25088
    ds_read_b64_tr_b16 v[44:45], v21 offset:24576
    ds_read_b64_tr_b16 v[46:47], v21 offset:25088
    ds_read_b128 v[36:39], v17 offset:24576
    v_mfma_f32_32x32x16_bf16 v[64:79], v[56:59], v[48:51], v[64:79]
    v_mfma_f32_32x32x16_bf16 v[96:111], v[60:63], v[48:51], v[96:111]
    v_mfma_f32_32x32x16_bf16 v[80:95], v[56:59], v[52:55], v[80:95]
    v_mfma_f32_32x32x16_bf16 v[112:127], v[60:63], v[52:55], v[112:127]
    ds_read_b128 v[48:51], v18 offset:24576
    ds_read_b64_tr_b16 v[56:57], v20 offset:26624
    ds_read_b64_tr_b16 v[58:59], v20 offset:27136
    ds_read_b64_tr_b16 v[60:61], v21 offset:26624
    ds_read_b64_tr_b16 v[62:63], v21 offset:27136
    ds_read_b128 v[52:55], v19 offset:24576
    s_waitcnt lgkmcnt(6)
    v_mfma_f32_32x32x16_bf16 v[64:79], v[40:43], v[32:35], v[64:79]
    v_mfma_f32_32x32x16_bf16 v[96:111], v[44:47], v[32:35], v[96:111]
    v_mfma_f32_32x32x16_bf16 v[80:95], v[40:43], v[36:39], v[80:95]
    v_mfma_f32_32x32x16_bf16 v[112:127], v[44:47], v[36:39], v[112:127]
    s_waitcnt lgkmcnt(0)
    s_barrier
    ds_read_b128 v[32:35], v10 offset:0
    ds_read_b64_tr_b16 v[40:41], v14 offset:0
    ds_read_b64_tr_b16 v[42:43], v14 offset:512
    ds_read_b64_tr_b16 v[44:45], v15 offset:0
    ds_read_b64_tr_b16 v[46:47], v15 offset:512
    ds_read_b128 v[36:39], v11 offset:0
    s_waitcnt vmcnt(0)
    v_mfma_f32_32x32x16_bf16 v[64:79], v[56:59], v[48:51], v[64:79]
    v_mfma_f32_32x32x16_bf16 v[96:111], v[60:63], v[48:51], v[96:111]
    v_mfma_f32_32x32x16_bf16 v[80:95], v[56:59], v[52:55], v[80:95]
    v_mfma_f32_32x32x16_bf16 v[112:127], v[60:63], v[52:55], v[112:127]
    ds_read_b128 v[48:51], v12 offset:0
    ds_read_b64_tr_b16 v[56:57], v14 offset:2048
    ds_read_b64_tr_b16 v[58:59], v14 offset:2560
    ds_read_b64_tr_b16 v[60:61], v15 offset:2048
    ds_read_b64_tr_b16 v[62:63], v15 offset:2560
    ds_read_b128 v[52:55], v13 offset:0
    s_waitcnt lgkmcnt(6)
    v_mfma_f32_32x32x16_bf16 v[64:79], v[40:43], v[32:35], v[64:79]
    v_mfma_f32_32x32x16_bf16 v[96:111], v[44:47], v[32:35], v[96:111]
    v_mfma_f32_32x32x16_bf16 v[80:95], v[40:43], v[36:39], v[80:95]
    v_mfma_f32_32x32x16_bf16 v[112:127], v[44:47], v[36:39], v[112:127]
    s_waitcnt lgkmcnt(0)
    s_barrier
    ds_read_b128 v[32:35], v10 offset:24576
    ds_read_b64_tr_b16 v[40:41], v14 offset:24576
    ds_read_b64_tr_b16 v[42:43], v14 offset:25088
    ds_read_b64_tr_b16 v[44:45], v15 offset:24576
    ds_read_b64_tr_b16 v[46:47], v15 offset:25088
    ds_read_b128 v[36:39], v11 offset:24576
    s_cmp_lg_u32 s32, 7
    s_cbranch_scc1 k_sp_1
k_spl_2:
    v_readfirstlane_b32 s33, v23
    s_nop 3
    s_cmp_ge_u32 s33, 32
    s_cbranch_scc1 k_spk_3
    s_sleep 8
    global_load_dword v23, v22, s[24:25] sc1
    s_waitcnt vmcnt(0)
    s_branch k_spl_2
k_spk_3:
    s_cmp_ge_u32 s49, 16
    s_cbranch_scc1 k_sp_1
    s_and_b32 s34, s48, 3
    s_mul_i32 s34, s34, 56
    s_and_b32 s33, s48, 4
    s_add_u32 s33, s33, s34
    s_lshl_b32 s33, s33, 9
    s_lshl_b32 s34, s49, 2
    s_add_u32 s33, s33, s34
    s_add_u32 s33, s33, 9240960
    v_lshrrev_b32 v26, 2, v1
    v_lshlrev_b32 v26, 12, v26
    v_and_b32 v27, 3, v1
    v_lshl_add_u32 v26, v27, 9, v26
    v_mov_b32 v27, 1
    s_mov_b32 exec_lo, 0xfffffff
    s_mov_b32 exec_hi, 0
    buffer_store_dword v27, v26, s[28:31], s33 offen sc1
    s_mov_b64 exec, -1
k_sp_1:
    v_mfma_f32_32x32x16_bf16 v[64:79], v[56:59], v[48:51], v[64:79]
    v_mfma_f32_32x32x16_bf16 v[96:111], v[60:63], v[48:51], v[96:111]
    v_mfma_f32_32x32x16_bf16 v[80:95], v[56:59], v[52:55], v[80:95]
    v_mfma_f32_32x32x16_bf16 v[112:127], v[60:63], v[52:55], v[112:127]
    ds_read_b128 v[48:51], v12 offset:24576
    ds_read_b64_tr_b16 v[56:57], v14 offset:26624
    ds_read_b64_tr_b16 v[58:59], v14 offset:27136
    ds_read_b64_tr_b16 v[60:61], v15 offset:26624
    ds_read_b64_tr_b16 v[62:63], v15 offset:27136
    ds_read_b128 v[52:55], v13 offset:24576
    s_waitcnt lgkmcnt(6)
    v_mfma_f32_32x32x16_bf16 v[64:79], v[40:43], v[32:35], v[64:79]
    v_mfma_f32_32x32x16_bf16 v[96:111], v[44:47], v[32:35], v[96:111]
    v_mfma_f32_32x32x16_bf16 v[80:95], v[40:43], v[36:39], v[80:95]
    v_mfma_f32_32x32x16_bf16 v[112:127], v[44:47], v[36:39], v[112:127]
    s_waitcnt lgkmcnt(0)
    s_barrier
    ds_read_b128 v[32:35], v16 offset:0
    ds_read_b64_tr_b16 v[40:41], v20 offset:0
    ds_read_b64_tr_b16 v[42:43], v20 offset:512
    ds_read_b64_tr_b16 v[44:45], v21 offset:0
    ds_read_b64_tr_b16 v[46:47], v21 offset:512
    ds_read_b128 v[36:39], v17 offset:0
    v_mfma_f32_32x32x16_bf16 v[64:79], v[56:59], v[48:51], v[64:79]
    v_mfma_f32_32x32x16_bf16 v[96:111], v[60:63], v[48:51], v[96:111]
    v_mfma_f32_32x32x16_bf16 v[80:95], v[56:59], v[52:55], v[80:95]
    v_mfma_f32_32x32x16_bf16 v[112:127], v[60:63], v[52:55], v[112:127]
    ds_read_b128 v[48:51], v18 offset:0
    ds_read_b64_tr_b16 v[56:57], v20 offset:2048
    ds_read_b64_tr_b16 v[58:59], v20 offset:2560
    ds_read_b64_tr_b16 v[60:61], v21 offset:2048
    ds_read_b64_tr_b16 v[62:63], v21 offset:2560
    ds_read_b128 v[52:55], v19 offset:0
    s_waitcnt lgkmcnt(6)
    v_mfma_f32_32x32x16_bf16 v[64:79], v[40:43], v[32:35], v[64:79]
    v_mfma_f32_32x32x16_bf16 v[96:111], v[44:47], v[32:35], v[96:111]
    v_mfma_f32_32x32x16_bf16 v[80:95], v[40:43], v[36:39], v[80:95]
    v_mfma_f32_32x32x16_bf16 v[112:127], v[44:47], v[36:39], v[112:127]
    s_waitcnt lgkmcnt(0)
    s_barrier
    ds_read_b128 v[32:35], v16 offset:24576
    ds_read_b64_tr_b16 v[40:41], v20 offset:24576
    ds_read_b64_tr_b16 v[42:43], v20 offset:25088
    ds_read_b64_tr_b16 v[44:45], v21 offset:24576
    ds_read_b64_tr_b16 v[46:47], v21 offset:25088
    ds_read_b128 v[36:39], v17 offset:24576
    v_mfma_f32_32x32x16_bf16 v[64:79], v[56:59], v[48:51], v[64:79]
    v_mfma_f32_32x32x16_bf16 v[96:111], v[60:63], v[48:51], v[96:111]
    v_mfma_f32_32x32x16_bf16 v[80:95], v[56:59], v[52:55], v[80:95]
    v_mfma_f32_32x32x16_bf16 v[112:127], v[60:63], v[52:55], v[112:127]
    ds_read_b128 v[48:51], v18 offset:24576
    ds_read_b64_tr_b16 v[56:57], v20 offset:26624
    ds_read_b64_tr_b16 v[58:59], v20 offset:27136
    ds_read_b64_tr_b16 v[60:61], v21 offset:26624
    ds_read_b64_tr_b16 v[62:63], v21 offset:27136
    ds_read_b128 v[52:55], v19 offset:24576
    s_waitcnt lgkmcnt(6)
    v_mfma_f32_32x32x16_bf16 v[64:79], v[40:43], v[32:35], v[64:79]
    v_mfma_f32_32x32x16_bf16 v[96:111], v[44:47], v[32:35], v[96:111]
    v_mfma_f32_32x32x16_bf16 v[80:95], v[40:43], v[36:39], v[80:95]
    v_mfma_f32_32x32x16_bf16 v[112:127], v[44:47], v[36:39], v[112:127]
    s_waitcnt lgkmcnt(0)
    s_barrier
    ds_read_b128 v[32:35], v10 offset:0
    ds_read_b64_tr_b16 v[40:41], v14 offset:0
    ds_read_b64_tr_b16 v[42:43], v14 offset:512
    ds_read_b64_tr_b16 v[44:45], v15 offset:0
    ds_read_b64_tr_b16 v[46:47], v15 offset:512
    ds_read_b128 v[36:39], v11 offset:0
    v_mfma_f32_32x32x16_bf16 v[64:79], v[56:59], v[48:51], v[64:79]
    v_mfma_f32_32x32x16_bf16 v[96:111], v[60:63], v[48:51], v[96:111]
    v_mfma_f32_32x32x16_bf16 v[80:95], v[56:59], v[52:55], v[80:95]
    v_mfma_f32_32x32x16_bf16 v[112:127], v[60:63], v[52:55], v[112:127]
    ds_read_b128 v[48:51], v12 offset:0
    ds_read_b64_tr_b16 v[56:57], v14 offset:2048
    ds_read_b64_tr_b16 v[58:59], v14 offset:2560
    ds_read_b64_tr_b16 v[60:61], v15 offset:2048
    ds_read_b64_tr_b16 v[62:63], v15 offset:2560
    ds_read_b128 v[52:55], v13 offset:0
    s_waitcnt lgkmcnt(6)
    v_mfma_f32_32x32x16_bf16 v[64:79], v[40:43], v[32:35], v[64:79]
    v_mfma_f32_32x32x16_bf16 v[96:111], v[44:47], v[32:35], v[96:111]
    v_mfma_f32_32x32x16_bf16 v[80:95], v[40:43], v[36:39], v[80:95]
    v_mfma_f32_32x32x16_bf16 v[112:127], v[44:47], v[36:39], v[112:127]
    s_waitcnt lgkmcnt(0)
    s_barrier
    ds_read_b128 v[32:35], v10 offset:24576
    ds_read_b64_tr_b16 v[40:41], v14 offset:24576
    ds_read_b64_tr_b16 v[42:43], v14 offset:25088
    ds_read_b64_tr_b16 v[44:45], v15 offset:24576
    ds_read_b64_tr_b16 v[46:47], v15 offset:25088
    ds_read_b128 v[36:39], v11 offset:24576
    s_cmp_lg_u32 s32, 7
    s_cbranch_scc1 k_s0_4
    s_waitcnt vmcnt(0)
    buffer_load_dword v25, v24, s[28:31], s57 offen offset:384 sc1
k_s0_4:
    v_mfma_f32_32x32x16_bf16 v[64:79], v[56:59], v[48:51], v[64:79]
    v_mfma_f32_32x32x16_bf16 v[96:111], v[60:63], v[48:51], v[96:111]
    v_mfma_f32_32x32x16_bf16 v[80:95], v[56:59], v[52:55], v[80:95]
    v_mfma_f32_32x32x16_bf16 v[112:127], v[60:63], v[52:55], v[112:127]
    ds_read_b128 v[48:51], v12 offset:24576
    ds_read_b64_tr_b16 v[56:57], v14 offset:26624
    ds_read_b64_tr_b16 v[58:59], v14 offset:27136
    ds_read_b64_tr_b16 v[60:61], v15 offset:26624
    ds_read_b64_tr_b16 v[62:63], v15 offset:27136
    ds_read_b128 v[52:55], v13 offset:24576
    s_waitcnt lgkmcnt(6)
    v_mfma_f32_32x32x16_bf16 v[64:79], v[40:43], v[32:35], v[64:79]
    v_mfma_f32_32x32x16_bf16 v[96:111], v[44:47], v[32:35], v[96:111]
    v_mfma_f32_32x32x16_bf16 v[80:95], v[40:43], v[36:39], v[80:95]
    v_mfma_f32_32x32x16_bf16 v[112:127], v[44:47], v[36:39], v[112:127]
    s_waitcnt lgkmcnt(0)
    s_barrier
    ds_read_b128 v[32:35], v16 offset:0
    ds_read_b64_tr_b16 v[40:41], v20 offset:0
    ds_read_b64_tr_b16 v[42:43], v20 offset:512
    ds_read_b64_tr_b16 v[44:45], v21 offset:0
    ds_read_b64_tr_b16 v[46:47], v21 offset:512
    ds_read_b128 v[36:39], v17 offset:0
    v_mfma_f32_32x32x16_bf16 v[64:79], v[56:59], v[48:51], v[64:79]
    v_mfma_f32_32x32x16_bf16 v[96:111], v[60:63], v[48:51], v[96:111]
    v_mfma_f32_32x32x16_bf16 v[80:95], v[56:59], v[52:55], v[80:95]
    v_mfma_f32_32x32x16_bf16 v[112:127], v[60:63], v[52:55], v[112:127]
    ds_read_b128 v[48:51], v18 offset:0
    ds_read_b64_tr_b16 v[56:57], v20 offset:2048
    ds_read_b64_tr_b16 v[58:59], v20 offset:2560
    ds_read_b64_tr_b16 v[60:61], v21 offset:2048
    ds_read_b64_tr_b16 v[62:63], v21 offset:2560
    ds_read_b128 v[52:55], v19 offset:0
    s_waitcnt lgkmcnt(6)
    v_mfma_f32_32x32x16_bf16 v[64:79], v[40:43], v[32:35], v[64:79]
    v_mfma_f32_32x32x16_bf16 v[96:111], v[44:47], v[32:35], v[96:111]
    v_mfma_f32_32x32x16_bf16 v[80:95], v[40:43], v[36:39], v[80:95]
    v_mfma_f32_32x32x16_bf16 v[112:127], v[44:47], v[36:39], v[112:127]
    s_waitcnt lgkmcnt(0)
    s_barrier
    ds_read_b128 v[32:35], v16 offset:24576
    ds_read_b64_tr_b16 v[40:41], v20 offset:24576
    ds_read_b64_tr_b16 v[42:43], v20 offset:25088
    ds_read_b64_tr_b16 v[44:45], v21 offset:24576
    ds_read_b64_tr_b16 v[46:47], v21 offset:25088
    ds_read_b128 v[36:39], v17 offset:24576
    s_cmp_lg_u32 s32, 7
    s_cbranch_scc1 k_s1_5
    s_cmp_eq_u32 s94, 1
    s_cbranch_scc1 k_s1_5
    s_waitcnt vmcnt(0)
    v_cmp_ne_u32 vcc, 1, v25
    s_nop 3
    s_cmp_lg_u64 vcc, 0
    s_cbranch_scc1 k_s1r_6
    v_lshlrev_b32 v26, 5, v1
    s_lshl_b32 s33, s48, 11
    s_add_u32 s33, s33, 9175040
    buffer_load_dwordx4 v[128:131], v26, s[28:31], s33 offen sc1
    buffer_load_dwordx4 v[132:135], v26, s[28:31], s33 offen offset:16 sc1
    s_mov_b32 s94, 1
    s_branch k_s1_5
k_s1r_6:
    buffer_load_dword v25, v24, s[28:31], s57 offen offset:384 sc1
k_s1_5:
    s_cmp_lg_u32 s54, 0
    s_cbranch_scc1 k_noew_7
    s_add_u32 m0, s95, 0
    s_add_u32 s33, s51, 0
    buffer_load_dwordx4 v9, s[40:43], s33 offen lds
    s_add_u32 m0, s95, 1024
    s_add_u32 s33, s51, 7168
    buffer_load_dwordx4 v9, s[40:43], s33 offen lds
    s_add_u32 m0, s95, 2048
    s_add_u32 s33, s51, 14336
    buffer_load_dwordx4 v9, s[40:43], s33 offen lds
    s_add_u32 m0, s95, 3072
    s_add_u32 s33, s51, 21504
    buffer_load_dwordx4 v9, s[40:43], s33 offen lds
    s_add_u32 m0, s95, 4096
    s_add_u32 s33, s51, 28672
    buffer_load_dwordx4 v9, s[40:43], s33 offen lds
    s_add_u32 m0, s95, 5120
    s_add_u32 s33, s51, 35840
    buffer_load_dwordx4 v9, s[40:43], s33 offen lds
    s_add_u32 m0, s95, 6144
    s_add_u32 s33, s51, 43008
    buffer_load_dwordx4 v9, s[40:43], s33 offen lds
    s_add_u32 m0, s95, 7168
    s_add_u32 s33, s51, 50176
    buffer_load_dwordx4 v9, s[40:43], s33 offen lds
    s_add_u32 m0, s95, 8192
    s_add_u32 s33, s51, 57344
    buffer_load_dwordx4 v9, s[40:43], s33 offen lds
    s_add_u32 m0, s95, 9216
    s_add_u32 s33, s51, 64512
    buffer_load_dwordx4 v9, s[40:43], s33 offen lds
    s_add_u32 m0, s95, 10240
    s_add_u32 s33, s51, 71680
    buffer_load_dwordx4 v9, s[40:43], s33 offen lds
    s_add_u32 m0, s95, 11264
    s_add_u32 s33, s51, 78848
    buffer_load_dwordx4 v9, s[40:43], s33 offen lds
k_noew_7:
    v_mfma_f32_32x32x16_bf16 v[64:79], v[56:59], v[48:51], v[64:79]
    v_mfma_f32_32x32x16_bf16 v[96:111], v[60:63], v[48:51], v[96:111]
    v_mfma_f32_32x32x16_bf16 v[80:95], v[56:59], v[52:55], v[80:95]
    v_mfma_f32_32x32x16_bf16 v[112:127], v[60:63], v[52:55], v[112:127]
    ds_read_b128 v[48:51], v18 offset:24576
    ds_read_b64_tr_b16 v[56:57], v20 offset:26624
    ds_read_b64_tr_b16 v[58:59], v20 offset:27136
    ds_read_b64_tr_b16 v[60:61], v21 offset:26624
    ds_read_b64_tr_b16 v[62:63], v21 offset:27136
    ds_read_b128 v[52:55], v19 offset:24576
    s_waitcnt lgkmcnt(6)
    v_mfma_f32_32x32x16_bf16 v[64:79], v[40:43], v[32:35], v[64:79]
    v_mfma_f32_32x32x16_bf16 v[96:111], v[44:47], v[32:35], v[96:111]
    v_mfma_f32_32x32x16_bf16 v[80:95], v[40:43], v[36:39], v[80:95]
    v_mfma_f32_32x32x16_bf16 v[112:127], v[44:47], v[36:39], v[112:127]
    s_waitcnt lgkmcnt(0)
    s_barrier
    ds_read_b128 v[32:35], v10 offset:0
    ds_read_b64_tr_b16 v[40:41], v14 offset:0
    ds_read_b64_tr_b16 v[42:43], v14 offset:512
    ds_read_b64_tr_b16 v[44:45], v15 offset:0
    ds_read_b64_tr_b16 v[46:47], v15 offset:512
    ds_read_b128 v[36:39], v11 offset:0
    s_cmp_lg_u32 s54, 1
    s_cbranch_scc1 k_noew_8
    s_add_u32 m0, s95, 0
    s_add_u32 s33, s51, 0
    buffer_load_dwordx4 v9, s[40:43], s33 offen lds
    s_add_u32 m0, s95, 1024
    s_add_u32 s33, s51, 7168
    buffer_load_dwordx4 v9, s[40:43], s33 offen lds
    s_add_u32 m0, s95, 2048
    s_add_u32 s33, s51, 14336
    buffer_load_dwordx4 v9, s[40:43], s33 offen lds
    s_add_u32 m0, s95, 3072
    s_add_u32 s33, s51, 21504
    buffer_load_dwordx4 v9, s[40:43], s33 offen lds
    s_add_u32 m0, s95, 4096
    s_add_u32 s33, s51, 28672
    buffer_load_dwordx4 v9, s[40:43], s33 offen lds
    s_add_u32 m0, s95, 5120
    s_add_u32 s33, s51, 35840
    buffer_load_dwordx4 v9, s[40:43], s33 offen lds
    s_add_u32 m0, s95, 6144
    s_add_u32 s33, s51, 43008
    buffer_load_dwordx4 v9, s[40:43], s33 offen lds
    s_add_u32 m0, s95, 7168
    s_add_u32 s33, s51, 50176
    buffer_load_dwordx4 v9, s[40:43], s33 offen lds
    s_add_u32 m0, s95, 8192
    s_add_u32 s33, s51, 57344
    buffer_load_dwordx4 v9, s[40:43], s33 offen lds
    s_add_u32 m0, s95, 9216
    s_add_u32 s33, s51, 64512
    buffer_load_dwordx4 v9, s[40:43], s33 offen lds
    s_add_u32 m0, s95, 10240
    s_add_u32 s33, s51, 71680
    buffer_load_dwordx4 v9, s[40:43], s33 offen lds
    s_add_u32 m0, s95, 11264
    s_add_u32 s33, s51, 78848
    buffer_load_dwordx4 v9, s[40:43], s33 offen lds
k_noew_8:
    v_mfma_f32_32x32x16_bf16 v[64:79], v[56:59], v[48:51], v[64:79]
    v_mfma_f32_32x32x16_bf16 v[96:111], v[60:63], v[48:51], v[96:111]
    v_mfma_f32_32x32x16_bf16 v[80:95], v[56:59], v[52:55], v[80:95]
    v_mfma_f32_32x32x16_bf16 v[112:127], v[60:63], v[52:55], v[112:127]
    ds_read_b128 v[48:51], v12 offset:0
    ds_read_b64_tr_b16 v[56:57], v14 offset:2048
    ds_read_b64_tr_b16 v[58:59], v14 offset:2560
    ds_read_b64_tr_b16 v[60:61], v15 offset:2048
    ds_read_b64_tr_b16 v[62:63], v15 offset:2560
    ds_read_b128 v[52:55], v13 offset:0
    s_waitcnt lgkmcnt(6)
    v_mfma_f32_32x32x16_bf16 v[64:79], v[40:43], v[32:35], v[64:79]
    v_mfma_f32_32x32x16_bf16 v[96:111], v[44:47], v[32:35], v[96:111]
    v_mfma_f32_32x32x16_bf16 v[80:95], v[40:43], v[36:39], v[80:95]
    v_mfma_f32_32x32x16_bf16 v[112:127], v[44:47], v[36:39], v[112:127]
    s_waitcnt lgkmcnt(0)
    s_barrier
    ds_read_b128 v[32:35], v10 offset:24576
    ds_read_b64_tr_b16 v[40:41], v14 offset:24576
    ds_read_b64_tr_b16 v[42:43], v14 offset:25088
    ds_read_b64_tr_b16 v[44:45], v15 offset:24576
    ds_read_b64_tr_b16 v[46:47], v15 offset:25088
    ds_read_b128 v[36:39], v11 offset:24576
    s_cmp_lg_u32 s32, 7
    s_cbranch_scc1 k_s1_9
    s_cmp_eq_u32 s94, 1
    s_cbranch_scc1 k_s1_9
    s_waitcnt vmcnt(0)
    v_cmp_ne_u32 vcc, 1, v25
    s_nop 3
    s_cmp_lg_u64 vcc, 0
    s_cbranch_scc1 k_s1r_10
    v_lshlrev_b32 v26, 5, v1
    s_lshl_b32 s33, s48, 11
    s_add_u32 s33, s33, 9175040
    buffer_load_dwordx4 v[128:131], v26, s[28:31], s33 offen sc1
    buffer_load_dwordx4 v[132:135], v26, s[28:31], s33 offen offset:16 sc1
    s_mov_b32 s94, 1
    s_branch k_s1_9
k_s1r_10:
    buffer_load_dword v25, v24, s[28:31], s57 offen offset:384 sc1
k_s1_9:
    s_cmp_lg_u32 s54, 2
    s_cbranch_scc1 k_noew_11
    s_add_u32 m0, s95, 0
    s_add_u32 s33, s51, 0
    buffer_load_dwordx4 v9, s[40:43], s33 offen lds
    s_add_u32 m0, s95, 1024
    s_add_u32 s33, s51, 7168
    buffer_load_dwordx4 v9, s[40:43], s33 offen lds
    s_add_u32 m0, s95, 2048
    s_add_u32 s33, s51, 14336
    buffer_load_dwordx4 v9, s[40:43], s33 offen lds
    s_add_u32 m0, s95, 3072
    s_add_u32 s33, s51, 21504
    buffer_load_dwordx4 v9, s[40:43], s33 offen lds
    s_add_u32 m0, s95, 4096
    s_add_u32 s33, s51, 28672
    buffer_load_dwordx4 v9, s[40:43], s33 offen lds
    s_add_u32 m0, s95, 5120
    s_add_u32 s33, s51, 35840
    buffer_load_dwordx4 v9, s[40:43], s33 offen lds
    s_add_u32 m0, s95, 6144
    s_add_u32 s33, s51, 43008
    buffer_load_dwordx4 v9, s[40:43], s33 offen lds
    s_add_u32 m0, s95, 7168
    s_add_u32 s33, s51, 50176
    buffer_load_dwordx4 v9, s[40:43], s33 offen lds
    s_add_u32 m0, s95, 8192
    s_add_u32 s33, s51, 57344
    buffer_load_dwordx4 v9, s[40:43], s33 offen lds
    s_add_u32 m0, s95, 9216
    s_add_u32 s33, s51, 64512
    buffer_load_dwordx4 v9, s[40:43], s33 offen lds
    s_add_u32 m0, s95, 10240
    s_add_u32 s33, s51, 71680
    buffer_load_dwordx4 v9, s[40:43], s33 offen lds
    s_add_u32 m0, s95, 11264
    s_add_u32 s33, s51, 78848
    buffer_load_dwordx4 v9, s[40:43], s33 offen lds
k_noew_11:
    v_mfma_f32_32x32x16_bf16 v[64:79], v[56:59], v[48:51], v[64:79]
    v_mfma_f32_32x32x16_bf16 v[96:111], v[60:63], v[48:51], v[96:111]
    v_mfma_f32_32x32x16_bf16 v[80:95], v[56:59], v[52:55], v[80:95]
    v_mfma_f32_32x32x16_bf16 v[112:127], v[60:63], v[52:55], v[112:127]
    ds_read_b128 v[48:51], v12 offset:24576
    ds_read_b64_tr_b16 v[56:57], v14 offset:26624
    ds_read_b64_tr_b16 v[58:59], v14 offset:27136
    ds_read_b64_tr_b16 v[60:61], v15 offset:26624
    ds_read_b64_tr_b16 v[62:63], v15 offset:27136
    ds_read_b128 v[52:55], v13 offset:24576
    s_waitcnt lgkmcnt(6)
    v_mfma_f32_32x32x16_bf16 v[64:79], v[40:43], v[32:35], v[64:79]
    v_mfma_f32_32x32x16_bf16 v[96:111], v[44:47], v[32:35], v[96:111]
    v_mfma_f32_32x32x16_bf16 v[80:95], v[40:43], v[36:39], v[80:95]
    v_mfma_f32_32x32x16_bf16 v[112:127], v[44:47], v[36:39], v[112:127]
    s_waitcnt lgkmcnt(0)
    v_mfma_f32_32x32x16_bf16 v[64:79], v[56:59], v[48:51], v[64:79]
    v_mfma_f32_32x32x16_bf16 v[96:111], v[60:63], v[48:51], v[96:111]
    v_mfma_f32_32x32x16_bf16 v[80:95], v[56:59], v[52:55], v[80:95]
    v_mfma_f32_32x32x16_bf16 v[112:127], v[60:63], v[52:55], v[112:127]
    s_setprio 2
    s_mov_b32 s40, s20
    s_and_b32 s41, s21, 0xffff
    s_mov_b32 s42, 1605632
    s_mov_b32 s43, 0x00020000
    v_lshlrev_b32 v10, 4, v1
    v_lshrrev_b32 v2, 3, v1
    v_mul_u32_u24 v2, 896, v2
    v_bfe_u32 v3, v1, 4, 1
    v_lshlrev_b32 v3, 2, v3
    v_and_b32 v4, 7, v1
    v_xor_b32 v3, v3, v4
    v_lshl_add_u32 v2, v3, 4, v2
    s_lshl_b32 s33, s53, 7
    v_add_u32 v11, s33, v2
    s_xor_b32 s95, s32, 4
    s_mul_i32 s95, s95, 12288
    s_mul_i32 s51, s32, 200704
    s_mul_i32 s58, s52, 448
    s_mul_i32 s33, s32, 28
    s_add_u32 s58, s58, s33
    s_lshl_b32 s58, s58, 9
    s_add_u32 s59, s58, 114688
    v_bfe_u32 v2, v1, 5, 1
    v_bfe_u32 v3, v1, 2, 2
    v_lshl_add_u32 v2, v2, 2, v3
    v_lshlrev_b32 v2, 7, v2
    v_bfe_u32 v3, v1, 4, 1
    v_and_b32 v4, 3, v1
    v_lshlrev_b32 v4, 3, v4
    v_lshl_or_b32 v4, v3, 5, v4
    v_bfe_u32 v3, v1, 3, 1
    v_lshl_or_b32 v4, v3, 6, v4
    v_add3_u32 v12, v2, v4, s95
    v_xor_b32 v13, 64, v12
    v_and_b32 v2, 31, v1
    s_lshl_b32 s33, s32, 5
    v_add_u32 v2, s33, v2
    v_lshlrev_b32 v3, 2, v2
    v_add_u32 v4, 141824, v3
    v_mov_b32 v3, v4
    v_and_b32 v5, 15, v1
    v_bfe_u32 v6, v1, 4, 1
    v_lshlrev_b32 v5, 4, v5
    v_lshl_add_u32 v5, v6, 10, v5
    s_lshl_b32 s33, s55, 9
    s_add_u32 s33, s33, 142848
    v_add_u32 v6, s33, v5
    v_lshlrev_b32 v2, 4, v1
    v_xor_b32 v3, 128, v3
    s_cmp_lg_u32 s32, 7
    s_cbranch_scc1 k_icd_12
    s_cmp_eq_u32 s94, 1
    s_cbranch_scc1 k_ick_15
k_icl_13:
    s_waitcnt vmcnt(0)
    v_cmp_ne_u32 vcc, 1, v25
    s_nop 3
    s_cmp_lg_u64 vcc, 0
    s_cbranch_scc1 k_icr_14
    v_lshlrev_b32 v26, 5, v1
    s_lshl_b32 s33, s48, 11
    s_add_u32 s33, s33, 9175040
    buffer_load_dwordx4 v[128:131], v26, s[28:31], s33 offen sc1
    buffer_load_dwordx4 v[132:135], v26, s[28:31], s33 offen offset:16 sc1
    s_branch k_ick_15
k_icr_14:
    s_sleep 2
    buffer_load_dword v25, v24, s[28:31], s57 offen offset:384 sc1
    s_branch k_icl_13
k_ick_15:
    s_waitcnt vmcnt(0)
    v_xor_b32 v136, 0x80000000, v128
    v_xor_b32 v137, 0x80000000, v130
    v_xor_b32 v138, 0x80000000, v132
    v_xor_b32 v139, 0x80000000, v134
    v_lshlrev_b32 v26, 4, v1
    v_add_u32 v26, 141824, v26
    ds_write_b128 v26, v[136:139]
k_icd_12:
    s_waitcnt lgkmcnt(0)
    s_barrier
    ds_read_b32 v28, v4
    ds_read_b32 v30, v3
    ds_read_b128 v[32:35], v6
    ds_read_b128 v[36:39], v6 offset:256
    v_cmp_gt_u32 vcc, 32, v1
    v_mov_b32 v43, 0
    v_mov_b32 v47, 0
    s_waitcnt lgkmcnt(2)
    v_lshrrev_b32 v40, 16, v28
    v_or_b32 v40, v40, v28
    v_cndmask_b32 v40, 0, v40, vcc
    v_mov_b32 v41, v40
    v_mov_b32 v42, v40
    v_lshrrev_b32 v44, 16, v30
    v_or_b32 v44, v44, v30
    v_cndmask_b32 v44, 0, v44, vcc
    v_mov_b32 v45, v44
    v_mov_b32 v46, v44
    s_waitcnt lgkmcnt(0)
    s_nop 0
    v_mfma_f32_32x32x16_bf16 v[64:79], v[32:35], v[40:43], v[64:79]
    v_mfma_f32_32x32x16_bf16 v[96:111], v[36:39], v[40:43], v[96:111]
    v_mfma_f32_32x32x16_bf16 v[80:95], v[32:35], v[44:47], v[80:95]
    v_mfma_f32_32x32x16_bf16 v[112:127], v[36:39], v[44:47], v[112:127]
    s_cmp_lg_u32 s54, 3
    s_cbranch_scc1 k_noew_16
    s_add_u32 m0, s95, 0
    s_add_u32 s33, s51, 0
    buffer_load_dwordx4 v9, s[40:43], s33 offen lds
    s_add_u32 m0, s95, 1024
    s_add_u32 s33, s51, 7168
    buffer_load_dwordx4 v9, s[40:43], s33 offen lds
    s_add_u32 m0, s95, 2048
    s_add_u32 s33, s51, 14336
    buffer_load_dwordx4 v9, s[40:43], s33 offen lds
    s_add_u32 m0, s95, 3072
    s_add_u32 s33, s51, 21504
    buffer_load_dwordx4 v9, s[40:43], s33 offen lds
    s_add_u32 m0, s95, 4096
    s_add_u32 s33, s51, 28672
    buffer_load_dwordx4 v9, s[40:43], s33 offen lds
    s_add_u32 m0, s95, 5120
    s_add_u32 s33, s51, 35840
    buffer_load_dwordx4 v9, s[40:43], s33 offen lds
    s_add_u32 m0, s95, 6144
    s_add_u32 s33, s51, 43008
    buffer_load_dwordx4 v9, s[40:43], s33 offen lds
    s_add_u32 m0, s95, 7168
    s_add_u32 s33, s51, 50176
    buffer_load_dwordx4 v9, s[40:43], s33 offen lds
    s_add_u32 m0, s95, 8192
    s_add_u32 s33, s51, 57344
    buffer_load_dwordx4 v9, s[40:43], s33 offen lds
    s_add_u32 m0, s95, 9216
    s_add_u32 s33, s51, 64512
    buffer_load_dwordx4 v9, s[40:43], s33 offen lds
    s_add_u32 m0, s95, 10240
    s_add_u32 s33, s51, 71680
    buffer_load_dwordx4 v9, s[40:43], s33 offen lds
    s_add_u32 m0, s95, 11264
    s_add_u32 s33, s51, 78848
    buffer_load_dwordx4 v9, s[40:43], s33 offen lds
k_noew_16:
    s_lshl_b32 s33, s48, 3
    s_lshl_b32 s34, s54, 1
    s_add_u32 s33, s33, s34
    s_xor_b32 s34, s55, 0
    s_add_u32 s33, s33, s34
    s_mul_i32 s33, s33, 224
    s_lshl_b32 s34, s49, 3
    s_add_u32 s33, s33, s34
    s_lshl_b32 s34, s55, 2
    s_add_u32 s33, s33, s34
    s_lshl_b32 s33, s33, 9
    s_nop 7
    v_max_f32 v64, 0, v64
    v_max_f32 v65, 0, v65
    v_max_f32 v66, 0, v66
    v_max_f32 v67, 0, v67
    v_max_f32 v68, 0, v68
    v_max_f32 v69, 0, v69
    v_max_f32 v70, 0, v70
    v_max_f32 v71, 0, v71
    v_pk_mul_f32 v[64:65], v[64:65], v[72:73]
    v_pk_mul_f32 v[66:67], v[66:67], v[74:75]
    v_pk_mul_f32 v[68:69], v[68:69], v[76:77]
    v_pk_mul_f32 v[70:71], v[70:71], v[78:79]
    v_cvt_pk_bf16_f32 v48, v64, v65
    v_cvt_pk_bf16_f32 v49, v66, v67
    v_cvt_pk_bf16_f32 v50, v68, v69
    v_cvt_pk_bf16_f32 v51, v70, v71
    buffer_store_dwordx4 v[48:51], v2, s[28:31], s33 offen offset:0 sc1
    v_max_f32 v96, 0, v96
    v_max_f32 v97, 0, v97
    v_max_f32 v98, 0, v98
    v_max_f32 v99, 0, v99
    v_max_f32 v100, 0, v100
    v_max_f32 v101, 0, v101
    v_max_f32 v102, 0, v102
    v_max_f32 v103, 0, v103
    v_pk_mul_f32 v[96:97], v[96:97], v[104:105]
    v_pk_mul_f32 v[98:99], v[98:99], v[106:107]
    v_pk_mul_f32 v[100:101], v[100:101], v[108:109]
    v_pk_mul_f32 v[102:103], v[102:103], v[110:111]
    v_cvt_pk_bf16_f32 v52, v96, v97
    v_cvt_pk_bf16_f32 v53, v98, v99
    v_cvt_pk_bf16_f32 v54, v100, v101
    v_cvt_pk_bf16_f32 v55, v102, v103
    buffer_store_dwordx4 v[52:55], v2, s[28:31], s33 offen offset:1024 sc1
    s_lshl_b32 s33, s48, 3
    s_lshl_b32 s34, s54, 1
    s_add_u32 s33, s33, s34
    s_xor_b32 s34, s55, 1
    s_add_u32 s33, s33, s34
    s_mul_i32 s33, s33, 224
    s_lshl_b32 s34, s49, 3
    s_add_u32 s33, s33, s34
    s_lshl_b32 s34, s55, 2
    s_add_u32 s33, s33, s34
    s_lshl_b32 s33, s33, 9
    v_max_f32 v80, 0, v80
    v_max_f32 v81, 0, v81
    v_max_f32 v82, 0, v82
    v_max_f32 v83, 0, v83
    v_max_f32 v84, 0, v84
    v_max_f32 v85, 0, v85
    v_max_f32 v86, 0, v86
    v_max_f32 v87, 0, v87
    v_pk_mul_f32 v[80:81], v[80:81], v[88:89]
    v_pk_mul_f32 v[82:83], v[82:83], v[90:91]
    v_pk_mul_f32 v[84:85], v[84:85], v[92:93]
    v_pk_mul_f32 v[86:87], v[86:87], v[94:95]
    v_cvt_pk_bf16_f32 v56, v80, v81
    v_cvt_pk_bf16_f32 v57, v82, v83
    v_cvt_pk_bf16_f32 v58, v84, v85
    v_cvt_pk_bf16_f32 v59, v86, v87
    buffer_store_dwordx4 v[56:59], v2, s[28:31], s33 offen offset:0 sc1
    v_max_f32 v112, 0, v112
    v_max_f32 v113, 0, v113
    v_max_f32 v114, 0, v114
    v_max_f32 v115, 0, v115
    v_max_f32 v116, 0, v116
    v_max_f32 v117, 0, v117
    v_max_f32 v118, 0, v118
    v_max_f32 v119, 0, v119
    v_pk_mul_f32 v[112:113], v[112:113], v[120:121]
    v_pk_mul_f32 v[114:115], v[114:115], v[122:123]
    v_pk_mul_f32 v[116:117], v[116:117], v[124:125]
    v_pk_mul_f32 v[118:119], v[118:119], v[126:127]
    v_cvt_pk_bf16_f32 v60, v112, v113
    v_cvt_pk_bf16_f32 v61, v114, v115
    v_cvt_pk_bf16_f32 v62, v116, v117
    v_cvt_pk_bf16_f32 v63, v118, v119
    buffer_store_dwordx4 v[60:63], v2, s[28:31], s33 offen offset:1024 sc1
    v_lshlrev_b32 v5, 12, v1
    s_waitcnt vmcnt(0)
    v_mov_b32 v2, 1
    v_mov_b32 v3, 153600
    s_mov_b64 exec, 1
    ds_add_rtn_u32 v4, v3, v2
    s_mov_b64 exec, -1
    s_waitcnt lgkmcnt(0)
    v_readfirstlane_b32 s92, v4
    s_nop 3
    s_cmp_lg_u32 s92, 7
    s_cbranch_scc1 nopub_17
    s_mov_b32 exec_lo, 0xfffffff
    s_mov_b32 exec_hi, 0
    buffer_store_dword v2, v5, s[28:31], s56 offen sc1
    s_mov_b64 exec, -1
nopub_17:
    s_setprio 0
    v_mov_b32 v3, 153604
gate_18:
    ds_read_b32 v2, v3
    s_waitcnt lgkmcnt(0)
    v_readfirstlane_b32 s33, v2
    s_nop 3
    s_cmp_eq_u32 s33, 4
    s_cbranch_scc1 gated_19
    s_sleep 1
    s_branch gate_18
gated_19:
    ds_read_b64_tr_b16 v[128:129], v12 offset:0
    ds_read_b64_tr_b16 v[130:131], v12 offset:1024
    ds_read_b64_tr_b16 v[132:133], v13 offset:0
    ds_read_b64_tr_b16 v[134:135], v13 offset:1024
    s_waitcnt lgkmcnt(0)
    s_add_u32 m0, s95, 0
    s_add_u32 s33, s51, 86016
    buffer_load_dwordx4 v11, s[40:43], s33 offen lds
    s_add_u32 m0, s95, 1024
    s_add_u32 s33, s51, 93184
    buffer_load_dwordx4 v11, s[40:43], s33 offen lds
    ds_read_b64_tr_b16 v[136:137], v12 offset:2048
    ds_read_b64_tr_b16 v[138:139], v12 offset:3072
    ds_read_b64_tr_b16 v[140:141], v13 offset:2048
    ds_read_b64_tr_b16 v[142:143], v13 offset:3072
    s_waitcnt lgkmcnt(0)
    s_add_u32 m0, s95, 2048
    s_add_u32 s33, s51, 100352
    buffer_load_dwordx4 v11, s[40:43], s33 offen lds
    s_add_u32 m0, s95, 3072
    s_add_u32 s33, s51, 107520
    buffer_load_dwordx4 v11, s[40:43], s33 offen lds
    ds_read_b64_tr_b16 v[144:145], v12 offset:4096
    ds_read_b64_tr_b16 v[146:147], v12 offset:5120
    ds_read_b64_tr_b16 v[148:149], v13 offset:4096
    ds_read_b64_tr_b16 v[150:151], v13 offset:5120
    s_waitcnt lgkmcnt(0)
    s_add_u32 m0, s95, 4096
    s_add_u32 s33, s51, 114688
    buffer_load_dwordx4 v11, s[40:43], s33 offen lds
    s_add_u32 m0, s95, 5120
    s_add_u32 s33, s51, 121856
    buffer_load_dwordx4 v11, s[40:43], s33 offen lds
    ds_read_b64_tr_b16 v[152:153], v12 offset:6144
    ds_read_b64_tr_b16 v[154:155], v12 offset:7168
    ds_read_b64_tr_b16 v[156:157], v13 offset:6144
    ds_read_b64_tr_b16 v[158:159], v13 offset:7168
    s_waitcnt lgkmcnt(0)
    s_add_u32 m0, s95, 6144
    s_add_u32 s33, s51, 129024
    buffer_load_dwordx4 v11, s[40:43], s33 offen lds
    s_add_u32 m0, s95, 7168
    s_add_u32 s33, s51, 136192
    buffer_load_dwordx4 v11, s[40:43], s33 offen lds
    ds_read_b64_tr_b16 v[160:161], v12 offset:8192
    ds_read_b64_tr_b16 v[162:163], v12 offset:9216
    ds_read_b64_tr_b16 v[164:165], v13 offset:8192
    ds_read_b64_tr_b16 v[166:167], v13 offset:9216
    s_waitcnt lgkmcnt(0)
    s_add_u32 m0, s95, 8192
    s_add_u32 s33, s51, 143360
    buffer_load_dwordx4 v11, s[40:43], s33 offen lds
    s_add_u32 m0, s95, 9216
    s_add_u32 s33, s51, 150528
    buffer_load_dwordx4 v11, s[40:43], s33 offen lds
    ds_read_b64_tr_b16 v[48:49], v12 offset:10240
    ds_read_b64_tr_b16 v[50:51], v12 offset:11264
    ds_read_b64_tr_b16 v[52:53], v13 offset:10240
    ds_read_b64_tr_b16 v[54:55], v13 offset:11264
    s_waitcnt lgkmcnt(0)
    s_add_u32 m0, s95, 10240
    s_add_u32 s33, s51, 157696
    buffer_load_dwordx4 v11, s[40:43], s33 offen lds
    s_add_u32 m0, s95, 11264
    s_add_u32 s33, s51, 164864
    buffer_load_dwordx4 v11, s[40:43], s33 offen lds
    s_waitcnt vmcnt(10)
    ds_read_b64_tr_b16 v[56:57], v12 offset:0
    ds_read_b64_tr_b16 v[58:59], v12 offset:1024
    ds_read_b64_tr_b16 v[60:61], v13 offset:0
    ds_read_b64_tr_b16 v[62:63], v13 offset:1024
    s_waitcnt lgkmcnt(0)
    s_add_u32 m0, s95, 0
    s_add_u32 s33, s51, 172032
    buffer_load_dwordx4 v11, s[40:43], s33 offen lds
    s_add_u32 m0, s95, 1024
    s_add_u32 s33, s51, 179200
    buffer_load_dwordx4 v11, s[40:43], s33 offen lds
    s_waitcnt vmcnt(10)
    s_waitcnt vmcnt(8)
    s_waitcnt vmcnt(6)
    s_waitcnt vmcnt(4)
    s_waitcnt vmcnt(2)
    s_waitcnt vmcnt(0)
    s_mul_i32 s93, s32, 7
    s_lshr_b32 s93, s93, 1
    s_lshl_b32 s93, s93, 2
    s_add_u32 s93, s93, s57
    v_and_b32 v3, 3, v1
    v_lshlrev_b32 v3, 2, v3
hpoll_20:
    buffer_load_dword v2, v3, s[28:31], s93 offen sc1
    s_waitcnt vmcnt(0)
    v_cmp_ne_u32 vcc, 1, v2
    s_nop 3
    s_cmp_eq_u64 vcc, 0
    s_cbranch_scc1 hpolled_21
    s_sleep 8
    s_branch hpoll_20
hpolled_21:
    s_add_u32 s33, s58, 0
    buffer_load_dwordx4 v[16:19], v10, s[28:31], s33 offen sc1
    s_add_u32 s33, s59, 0
    buffer_load_dwordx4 v[20:23], v10, s[28:31], s33 offen sc1
    s_add_u32 s33, s58, 1024
    buffer_load_dwordx4 v[24:27], v10, s[28:31], s33 offen sc1
    s_add_u32 s33, s59, 1024
    buffer_load_dwordx4 v[28:31], v10, s[28:31], s33 offen sc1
    s_add_u32 s33, s58, 2048
    buffer_load_dwordx4 v[32:35], v10, s[28:31], s33 offen sc1
    s_add_u32 s33, s59, 2048
    buffer_load_dwordx4 v[36:39], v10, s[28:31], s33 offen sc1
    s_add_u32 s33, s58, 3072
    buffer_load_dwordx4 v[40:43], v10, s[28:31], s33 offen sc1
    s_add_u32 s33, s59, 3072
    buffer_load_dwordx4 v[44:47], v10, s[28:31], s33 offen sc1
    s_waitcnt vmcnt(6) lgkmcnt(0)
    v_mfma_f32_32x32x16_bf16 v[64:79], v[128:131], v[16:19], 0
    v_mfma_f32_32x32x16_bf16 v[96:111], v[132:135], v[16:19], 0
    v_mfma_f32_32x32x16_bf16 v[80:95], v[128:131], v[20:23], 0
    v_mfma_f32_32x32x16_bf16 v[112:127], v[132:135], v[20:23], 0
    s_add_u32 s33, s58, 4096
    buffer_load_dwordx4 v[16:19], v10, s[28:31], s33 offen sc1
    s_add_u32 s33, s59, 4096
    buffer_load_dwordx4 v[20:23], v10, s[28:31], s33 offen sc1
    ds_read_b64_tr_b16 v[128:129], v12 offset:2048
    ds_read_b64_tr_b16 v[130:131], v12 offset:3072
    ds_read_b64_tr_b16 v[132:133], v13 offset:2048
    ds_read_b64_tr_b16 v[134:135], v13 offset:3072
    s_waitcnt lgkmcnt(0)
    s_add_u32 m0, s95, 2048
    s_add_u32 s33, s51, 186368
    buffer_load_dwordx4 v11, s[40:43], s33 offen lds
    s_add_u32 m0, s95, 3072
    s_add_u32 s33, s51, 193536
    buffer_load_dwordx4 v11, s[40:43], s33 offen lds
    s_waitcnt vmcnt(8)
    v_mfma_f32_32x32x16_bf16 v[64:79], v[136:139], v[24:27], v[64:79]
    v_mfma_f32_32x32x16_bf16 v[96:111], v[140:143], v[24:27], v[96:111]
    v_mfma_f32_32x32x16_bf16 v[80:95], v[136:139], v[28:31], v[80:95]
    v_mfma_f32_32x32x16_bf16 v[112:127], v[140:143], v[28:31], v[112:127]
    s_add_u32 s33, s58, 5120
    buffer_load_dwordx4 v[24:27], v10, s[28:31], s33 offen sc1
    s_add_u32 s33, s59, 5120
    buffer_load_dwordx4 v[28:31], v10, s[28:31], s33 offen sc1
    ds_read_b64_tr_b16 v[136:137], v12 offset:4096
    ds_read_b64_tr_b16 v[138:139], v12 offset:5120
    ds_read_b64_tr_b16 v[140:141], v13 offset:4096
    ds_read_b64_tr_b16 v[142:143], v13 offset:5120
    s_waitcnt vmcnt(8)
    v_mfma_f32_32x32x16_bf16 v[64:79], v[144:147], v[32:35], v[64:79]
    v_mfma_f32_32x32x16_bf16 v[96:111], v[148:151], v[32:35], v[96:111]
    v_mfma_f32_32x32x16_bf16 v[80:95], v[144:147], v[36:39], v[80:95]
    v_mfma_f32_32x32x16_bf16 v[112:127], v[148:151], v[36:39], v[112:127]
    s_add_u32 s33, s58, 6144
    buffer_load_dwordx4 v[32:35], v10, s[28:31], s33 offen sc1
    s_add_u32 s33, s59, 6144
    buffer_load_dwordx4 v[36:39], v10, s[28:31], s33 offen sc1
    ds_read_b64_tr_b16 v[144:145], v12 offset:6144
    ds_read_b64_tr_b16 v[146:147], v12 offset:7168
    ds_read_b64_tr_b16 v[148:149], v13 offset:6144
    ds_read_b64_tr_b16 v[150:151], v13 offset:7168
    s_waitcnt vmcnt(8)
    v_mfma_f32_32x32x16_bf16 v[64:79], v[152:155], v[40:43], v[64:79]
    v_mfma_f32_32x32x16_bf16 v[96:111], v[156:159], v[40:43], v[96:111]
    v_mfma_f32_32x32x16_bf16 v[80:95], v[152:155], v[44:47], v[80:95]
    v_mfma_f32_32x32x16_bf16 v[112:127], v[156:159], v[44:47], v[112:127]
    s_add_u32 s33, s58, 7168
    buffer_load_dwordx4 v[40:43], v10, s[28:31], s33 offen sc1
    s_add_u32 s33, s59, 7168
    buffer_load_dwordx4 v[44:47], v10, s[28:31], s33 offen sc1
    ds_read_b64_tr_b16 v[152:153], v12 offset:8192
    ds_read_b64_tr_b16 v[154:155], v12 offset:9216
    ds_read_b64_tr_b16 v[156:157], v13 offset:8192
    ds_read_b64_tr_b16 v[158:159], v13 offset:9216
    s_waitcnt vmcnt(8)
    v_mfma_f32_32x32x16_bf16 v[64:79], v[160:163], v[16:19], v[64:79]
    v_mfma_f32_32x32x16_bf16 v[96:111], v[164:167], v[16:19], v[96:111]
    v_mfma_f32_32x32x16_bf16 v[80:95], v[160:163], v[20:23], v[80:95]
    v_mfma_f32_32x32x16_bf16 v[112:127], v[164:167], v[20:23], v[112:127]
    s_add_u32 s33, s58, 8192
    buffer_load_dwordx4 v[16:19], v10, s[28:31], s33 offen sc1
    s_add_u32 s33, s59, 8192
    buffer_load_dwordx4 v[20:23], v10, s[28:31], s33 offen sc1
    ds_read_b64_tr_b16 v[160:161], v12 offset:10240
    ds_read_b64_tr_b16 v[162:163], v12 offset:11264
    ds_read_b64_tr_b16 v[164:165], v13 offset:10240
    ds_read_b64_tr_b16 v[166:167], v13 offset:11264
    s_waitcnt vmcnt(6)
    v_mfma_f32_32x32x16_bf16 v[64:79], v[48:51], v[24:27], v[64:79]
    v_mfma_f32_32x32x16_bf16 v[96:111], v[52:55], v[24:27], v[96:111]
    v_mfma_f32_32x32x16_bf16 v[80:95], v[48:51], v[28:31], v[80:95]
    v_mfma_f32_32x32x16_bf16 v[112:127], v[52:55], v[28:31], v[112:127]
    s_add_u32 s33, s58, 9216
    buffer_load_dwordx4 v[24:27], v10, s[28:31], s33 offen sc1
    s_add_u32 s33, s59, 9216
    buffer_load_dwordx4 v[28:31], v10, s[28:31], s33 offen sc1
    ds_read_b64_tr_b16 v[48:49], v12 offset:0
    ds_read_b64_tr_b16 v[50:51], v12 offset:1024
    ds_read_b64_tr_b16 v[52:53], v13 offset:0
    ds_read_b64_tr_b16 v[54:55], v13 offset:1024
    s_waitcnt vmcnt(6)
    v_mfma_f32_32x32x16_bf16 v[64:79], v[56:59], v[32:35], v[64:79]
    v_mfma_f32_32x32x16_bf16 v[96:111], v[60:63], v[32:35], v[96:111]
    v_mfma_f32_32x32x16_bf16 v[80:95], v[56:59], v[36:39], v[80:95]
    v_mfma_f32_32x32x16_bf16 v[112:127], v[60:63], v[36:39], v[112:127]
    s_add_u32 s33, s58, 10240
    buffer_load_dwordx4 v[32:35], v10, s[28:31], s33 offen sc1
    s_add_u32 s33, s59, 10240
    buffer_load_dwordx4 v[36:39], v10, s[28:31], s33 offen sc1
    s_waitcnt vmcnt(6) lgkmcnt(0)
    v_mfma_f32_32x32x16_bf16 v[64:79], v[128:131], v[40:43], v[64:79]
    v_mfma_f32_32x32x16_bf16 v[96:111], v[132:135], v[40:43], v[96:111]
    v_mfma_f32_32x32x16_bf16 v[80:95], v[128:131], v[44:47], v[80:95]
    v_mfma_f32_32x32x16_bf16 v[112:127], v[132:135], v[44:47], v[112:127]
    s_add_u32 s33, s58, 11264
    buffer_load_dwordx4 v[40:43], v10, s[28:31], s33 offen sc1
    s_add_u32 s33, s59, 11264
    buffer_load_dwordx4 v[44:47], v10, s[28:31], s33 offen sc1
    s_waitcnt vmcnt(6)
    v_mfma_f32_32x32x16_bf16 v[64:79], v[136:139], v[16:19], v[64:79]
    v_mfma_f32_32x32x16_bf16 v[96:111], v[140:143], v[16:19], v[96:111]
    v_mfma_f32_32x32x16_bf16 v[80:95], v[136:139], v[20:23], v[80:95]
    v_mfma_f32_32x32x16_bf16 v[112:127], v[140:143], v[20:23], v[112:127]
    s_add_u32 s33, s58, 12288
    buffer_load_dwordx4 v[16:19], v10, s[28:31], s33 offen sc1
    s_add_u32 s33, s59, 12288
    buffer_load_dwordx4 v[20:23], v10, s[28:31], s33 offen sc1
    s_waitcnt vmcnt(16)
    ds_read_b64_tr_b16 v[56:57], v12 offset:2048
    ds_read_b64_tr_b16 v[58:59], v12 offset:3072
    ds_read_b64_tr_b16 v[60:61], v13 offset:2048
    ds_read_b64_tr_b16 v[62:63], v13 offset:3072
    s_waitcnt vmcnt(6)
    v_mfma_f32_32x32x16_bf16 v[64:79], v[144:147], v[24:27], v[64:79]
    v_mfma_f32_32x32x16_bf16 v[96:111], v[148:151], v[24:27], v[96:111]
    v_mfma_f32_32x32x16_bf16 v[80:95], v[144:147], v[28:31], v[80:95]
    v_mfma_f32_32x32x16_bf16 v[112:127], v[148:151], v[28:31], v[112:127]
    s_add_u32 s33, s58, 13312
    buffer_load_dwordx4 v[24:27], v10, s[28:31], s33 offen sc1
    s_add_u32 s33, s59, 13312
    buffer_load_dwordx4 v[28:31], v10, s[28:31], s33 offen sc1
    s_lshl_b32 s33, s52, 6
    v_lshrrev_b32 v2, 3, v0
    v_add_u32 v3, s33, v2
    s_movk_i32 s34, 896
    v_mul_lo_u32 v4, v3, s34
    v_and_b32 v5, 7, v0
    v_lshl_add_u32 v4, v5, 4, v4
    s_lshl_b32 s33, s53, 7
    v_add_u32 v14, s33, v4
    s_mov_b32 s36, s4
    s_and_b32 s37, s5, 0xffff
    s_mov_b32 s38, 1835008
    s_mov_b32 s39, 0x00020000
    buffer_load_dwordx4 v[128:131], v14, s[36:39], 0 offen
    s_waitcnt vmcnt(7)
    v_mfma_f32_32x32x16_bf16 v[64:79], v[152:155], v[32:35], v[64:79]
    v_mfma_f32_32x32x16_bf16 v[96:111], v[156:159], v[32:35], v[96:111]
    v_mfma_f32_32x32x16_bf16 v[80:95], v[152:155], v[36:39], v[80:95]
    v_mfma_f32_32x32x16_bf16 v[112:127], v[156:159], v[36:39], v[112:127]
    s_waitcnt vmcnt(5)
    v_mfma_f32_32x32x16_bf16 v[64:79], v[160:163], v[40:43], v[64:79]
    v_mfma_f32_32x32x16_bf16 v[96:111], v[164:167], v[40:43], v[96:111]
    v_mfma_f32_32x32x16_bf16 v[80:95], v[160:163], v[44:47], v[80:95]
    v_mfma_f32_32x32x16_bf16 v[112:127], v[164:167], v[44:47], v[112:127]
    s_waitcnt vmcnt(3)
    v_mfma_f32_32x32x16_bf16 v[64:79], v[48:51], v[16:19], v[64:79]
    v_mfma_f32_32x32x16_bf16 v[96:111], v[52:55], v[16:19], v[96:111]
    v_mfma_f32_32x32x16_bf16 v[80:95], v[48:51], v[20:23], v[80:95]
    v_mfma_f32_32x32x16_bf16 v[112:127], v[52:55], v[20:23], v[112:127]
    s_waitcnt vmcnt(1) lgkmcnt(0)
    v_mfma_f32_32x32x16_bf16 v[64:79], v[56:59], v[24:27], v[64:79]
    v_mfma_f32_32x32x16_bf16 v[96:111], v[60:63], v[24:27], v[96:111]
    v_mfma_f32_32x32x16_bf16 v[80:95], v[56:59], v[28:31], v[80:95]
    v_mfma_f32_32x32x16_bf16 v[112:127], v[60:63], v[28:31], v[112:127]
    v_and_b32 v2, 31, v1
    v_lshrrev_b32 v3, 5, v1
    v_and_b32 v4, 7, v1
    v_xor_b32 v3, v3, v4
    v_lshlrev_b32 v3, 4, v3
    v_lshl_add_u32 v2, v2, 7, v3
    v_add_u32 v16, s95, v2
    s_lshl_b32 s33, s32, 12
    s_add_u32 s33, s33, 98304
    v_add_u32 v24, s33, v2
    v_xor_b32 v17, 16, v16
    v_xor_b32 v18, 32, v16
    v_xor_b32 v19, 48, v16
    v_xor_b32 v20, 64, v16
    v_xor_b32 v21, 80, v16
    v_xor_b32 v22, 96, v16
    v_xor_b32 v23, 112, v16
    v_xor_b32 v25, 16, v24
    v_xor_b32 v27, 48, v24
    v_xor_b32 v29, 80, v24
    v_xor_b32 v31, 112, v24
    ds_write_b128 v16, v[64:67] offset:0
    ds_write_b128 v18, v[68:71] offset:0
    ds_write_b128 v20, v[72:75] offset:0
    ds_write_b128 v22, v[76:79] offset:0
    ds_write_b128 v17, v[96:99] offset:4096
    ds_write_b128 v19, v[100:103] offset:4096
    ds_write_b128 v21, v[104:107] offset:4096
    ds_write_b128 v23, v[108:111] offset:4096
    ds_write_b128 v16, v[80:83] offset:8192
    ds_write_b128 v18, v[84:87] offset:8192
    ds_write_b128 v20, v[88:91] offset:8192
    ds_write_b128 v22, v[92:95] offset:8192
    v_mov_b32 v4, 153608
pwait_22:
    ds_read_b32 v2, v4
    s_waitcnt lgkmcnt(0)
    v_readfirstlane_b32 s33, v2
    s_nop 3
    s_cmp_eq_u32 s33, 4
    s_cbranch_scc1 pwaited_23
    s_sleep 1
    s_branch pwait_22
pwaited_23:
    ds_write_b128 v25, v[112:115]
    ds_write_b128 v27, v[116:119]
    ds_write_b128 v29, v[120:123]
    ds_write_b128 v31, v[124:127]
    s_branch k_final
k_helper:
    s_sub_u32 s54, s32, 8
    s_lshr_b32 s55, s54, 1
    s_lshl_b32 s56, s54, 12
    s_lshl_b32 s57, s54, 11
    s_add_u32 s57, s57, 16384
    s_lshl_b32 s33, s48, 8
    s_lshl_b32 s34, s54, 6
    s_add_u32 s33, s33, s34
    v_lshrrev_b32 v2, 2, v1
    v_add_u32 v2, s33, v2
    s_movk_i32 s34, 896
    v_mul_lo_u32 v2, v2, s34
    v_and_b32 v3, 3, v1
    v_bfe_u32 v4, v1, 4, 2
    v_xor_b32 v3, v3, v4
    v_lshl_add_u32 v10, v3, 4, v2
    s_and_b32 s33, s54, 1
    s_lshl_b32 s33, s33, 4
    v_lshrrev_b32 v2, 3, v1
    v_add_u32 v2, s33, v2
    s_movk_i32 s34, 3584
    v_mul_lo_u32 v2, v2, s34
    s_lshl_b32 s33, s49, 7
    v_add_u32 v2, s33, v2
    v_bfe_u32 v4, v1, 4, 1
    v_lshlrev_b32 v4, 1, v4
    s_lshl_b32 s33, s55, 2
    v_or_b32 v4, s33, v4
    v_and_b32 v3, 7, v1
    v_xor_b32 v5, v3, v4
    v_lshl_add_u32 v11, v5, 4, v2
    s_waitcnt lgkmcnt(0)
    s_mov_b32 s36, s4
    s_and_b32 s37, s5, 0xffff
    s_mov_b32 s38, 1835008
    s_mov_b32 s39, 0x00020000
    s_cmp_eq_u32 s55, 1
    s_cselect_b32 s40, s18, s16
    s_cselect_b32 s41, s19, s17
    s_and_b32 s41, s41, 0xffff
    s_mov_b32 s42, 1605632
    s_mov_b32 s43, 0x00020000
    s_add_u32 m0, s57, 0
    s_mov_b32 s33, 0
    buffer_load_dwordx4 v11, s[40:43], s33 offen lds
    s_add_u32 m0, s57, 1024
    s_mov_b32 s33, 28672
    buffer_load_dwordx4 v11, s[40:43], s33 offen lds
    s_add_u32 m0, s56, 0
    s_mov_b32 s33, 0
    buffer_load_dwordx4 v10, s[36:39], s33 offen lds
    s_add_u32 m0, s56, 1024
    s_mov_b32 s33, 14336
    buffer_load_dwordx4 v10, s[36:39], s33 offen lds
    s_add_u32 m0, s56, 2048
    s_mov_b32 s33, 28672
    buffer_load_dwordx4 v10, s[36:39], s33 offen lds
    s_add_u32 m0, s56, 3072
    s_mov_b32 s33, 43008
    buffer_load_dwordx4 v10, s[36:39], s33 offen lds
    s_add_u32 m0, s57, 24576
    s_mov_b32 s33, 114688
    buffer_load_dwordx4 v11, s[40:43], s33 offen lds
    s_add_u32 m0, s57, 25600
    s_mov_b32 s33, 143360
    buffer_load_dwordx4 v11, s[40:43], s33 offen lds
    s_add_u32 m0, s56, 24576
    s_mov_b32 s33, 64
    buffer_load_dwordx4 v10, s[36:39], s33 offen lds
    s_add_u32 m0, s56, 25600
    s_mov_b32 s33, 14400
    buffer_load_dwordx4 v10, s[36:39], s33 offen lds
    s_add_u32 m0, s56, 26624
    s_mov_b32 s33, 28736
    buffer_load_dwordx4 v10, s[36:39], s33 offen lds
    s_add_u32 m0, s56, 27648
    s_mov_b32 s33, 43072
    buffer_load_dwordx4 v10, s[36:39], s33 offen lds
    s_mov_b32 s28, s26
    s_and_b32 s29, s27, 0xffff
    s_mov_b32 s30, 16777216
    s_mov_b32 s31, 0x00020000
    v_lshrrev_b32 v2, 3, v1
    v_lshlrev_b32 v2, 7, v2
    v_lshl_add_u32 v2, v5, 4, v2
    v_add_u32 v20, s57, v2
    v_add_u32 v21, 49152, v20
    v_mov_b32 v24, 0
    v_mov_b32 v25, 0
    v_mov_b32 v26, 0
    v_mov_b32 v27, 0
    v_mov_b32 v28, 0
    v_mov_b32 v29, 0
    v_mov_b32 v30, 0
    v_mov_b32 v31, 0
    v_lshlrev_b32 v9, 4, v1
    s_lshl_b32 s58, s2, 1
    s_add_u32 s58, s58, s55
    s_lshl_b32 s59, s58, 12
    s_add_u32 s44, s12, s59
    s_addc_u32 s45, s13, 0
    s_and_b32 s45, s45, 0xffff
    s_movk_i32 s46, 4096
    s_mov_b32 s47, 0x00020000
    s_lshl_b32 s33, s2, 2
    s_load_dword s95, s[14:15], s33
    v_subrev_u32 v12, 32, v9
    v_subrev_u32 v13, 16, v9
    v_add_u32 v14, 992, v9
    s_mul_i32 s93, s55, 21760
    s_add_u32 s93, s93, 98304
    s_add_u32 s94, s93, 16640
    v_add_u32 v15, s93, v9
    s_waitcnt vmcnt(6)
    s_barrier
    ds_read_b128 v[32:35], v20 offset:0
    ds_read_b128 v[36:39], v20 offset:1024
    s_add_u32 m0, s57, 49152
    s_mov_b32 s33, 229376
    buffer_load_dwordx4 v11, s[40:43], s33 offen lds
    s_add_u32 m0, s57, 50176
    s_mov_b32 s33, 258048
    buffer_load_dwordx4 v11, s[40:43], s33 offen lds
    s_add_u32 m0, s56, 49152
    s_mov_b32 s33, 128
    buffer_load_dwordx4 v10, s[36:39], s33 offen lds
    s_add_u32 m0, s56, 50176
    s_mov_b32 s33, 14464
    buffer_load_dwordx4 v10, s[36:39], s33 offen lds
    s_add_u32 m0, s56, 51200
    s_mov_b32 s33, 28800
    buffer_load_dwordx4 v10, s[36:39], s33 offen lds
    s_add_u32 m0, s56, 52224
    s_mov_b32 s33, 43136
    buffer_load_dwordx4 v10, s[36:39], s33 offen lds
    s_waitcnt vmcnt(6) lgkmcnt(0)
    s_barrier
    ds_read_b128 v[40:43], v20 offset:24576
    ds_read_b128 v[44:47], v20 offset:25600
    s_add_u32 m0, s57, 73728
    s_mov_b32 s33, 344064
    buffer_load_dwordx4 v11, s[40:43], s33 offen lds
    s_add_u32 m0, s57, 74752
    s_mov_b32 s33, 372736
    buffer_load_dwordx4 v11, s[40:43], s33 offen lds
    s_add_u32 m0, s56, 73728
    s_mov_b32 s33, 192
    buffer_load_dwordx4 v10, s[36:39], s33 offen lds
    s_add_u32 m0, s56, 74752
    s_mov_b32 s33, 14528
    buffer_load_dwordx4 v10, s[36:39], s33 offen lds
    s_add_u32 m0, s56, 75776
    s_mov_b32 s33, 28864
    buffer_load_dwordx4 v10, s[36:39], s33 offen lds
    s_add_u32 m0, s56, 76800
    s_mov_b32 s33, 43200
    buffer_load_dwordx4 v10, s[36:39], s33 offen lds
    s_add_u32 m0, s57, 0
    s_mov_b32 s33, 458752
    buffer_load_dwordx4 v11, s[40:43], s33 offen lds
    s_add_u32 m0, s57, 1024
    s_mov_b32 s33, 487424
    buffer_load_dwordx4 v11, s[40:43], s33 offen lds
    s_add_u32 m0, s56, 0
    s_mov_b32 s33, 256
    buffer_load_dwordx4 v10, s[36:39], s33 offen lds
    s_add_u32 m0, s56, 1024
    s_mov_b32 s33, 14592
    buffer_load_dwordx4 v10, s[36:39], s33 offen lds
    s_add_u32 m0, s56, 2048
    s_mov_b32 s33, 28928
    buffer_load_dwordx4 v10, s[36:39], s33 offen lds
    s_add_u32 m0, s56, 3072
    s_mov_b32 s33, 43264
    buffer_load_dwordx4 v10, s[36:39], s33 offen lds
    v_lshlrev_b32 v48, 16, v32
    v_and_b32 v49, 0xffff0000, v32
    v_add_f32 v24, v24, v48
    v_add_f32 v25, v25, v49
    v_lshlrev_b32 v50, 16, v33
    v_and_b32 v51, 0xffff0000, v33
    v_add_f32 v26, v26, v50
    v_add_f32 v27, v27, v51
    v_lshlrev_b32 v48, 16, v34
    v_and_b32 v49, 0xffff0000, v34
    v_add_f32 v28, v28, v48
    v_add_f32 v29, v29, v49
    v_lshlrev_b32 v50, 16, v35
    v_and_b32 v51, 0xffff0000, v35
    v_add_f32 v30, v30, v50
    v_add_f32 v31, v31, v51
    v_lshlrev_b32 v48, 16, v36
    v_and_b32 v49, 0xffff0000, v36
    v_add_f32 v24, v24, v48
    v_add_f32 v25, v25, v49
    v_lshlrev_b32 v50, 16, v37
    v_and_b32 v51, 0xffff0000, v37
    v_add_f32 v26, v26, v50
    v_add_f32 v27, v27, v51
    v_lshlrev_b32 v48, 16, v38
    v_and_b32 v49, 0xffff0000, v38
    v_add_f32 v28, v28, v48
    v_add_f32 v29, v29, v49
    v_lshlrev_b32 v50, 16, v39
    v_and_b32 v51, 0xffff0000, v39
    v_add_f32 v30, v30, v50
    v_add_f32 v31, v31, v51
    s_waitcnt vmcnt(12) lgkmcnt(0)
    s_barrier
    ds_read_b128 v[32:35], v21 offset:0
    ds_read_b128 v[36:39], v21 offset:1024
    s_add_u32 m0, s57, 24576
    s_mov_b32 s33, 573440
    buffer_load_dwordx4 v11, s[40:43], s33 offen lds
    s_add_u32 m0, s57, 25600
    s_mov_b32 s33, 602112
    buffer_load_dwordx4 v11, s[40:43], s33 offen lds
    s_add_u32 m0, s56, 24576
    s_mov_b32 s33, 320
    buffer_load_dwordx4 v10, s[36:39], s33 offen lds
    s_add_u32 m0, s56, 25600
    s_mov_b32 s33, 14656
    buffer_load_dwordx4 v10, s[36:39], s33 offen lds
    s_add_u32 m0, s56, 26624
    s_mov_b32 s33, 28992
    buffer_load_dwordx4 v10, s[36:39], s33 offen lds
    s_add_u32 m0, s56, 27648
    s_mov_b32 s33, 43328
    buffer_load_dwordx4 v10, s[36:39], s33 offen lds
    v_lshlrev_b32 v48, 16, v40
    v_and_b32 v49, 0xffff0000, v40
    v_add_f32 v24, v24, v48
    v_add_f32 v25, v25, v49
    v_lshlrev_b32 v50, 16, v41
    v_and_b32 v51, 0xffff0000, v41
    v_add_f32 v26, v26, v50
    v_add_f32 v27, v27, v51
    v_lshlrev_b32 v48, 16, v42
    v_and_b32 v49, 0xffff0000, v42
    v_add_f32 v28, v28, v48
    v_add_f32 v29, v29, v49
    v_lshlrev_b32 v50, 16, v43
    v_and_b32 v51, 0xffff0000, v43
    v_add_f32 v30, v30, v50
    v_add_f32 v31, v31, v51
    v_lshlrev_b32 v48, 16, v44
    v_and_b32 v49, 0xffff0000, v44
    v_add_f32 v24, v24, v48
    v_add_f32 v25, v25, v49
    v_lshlrev_b32 v50, 16, v45
    v_and_b32 v51, 0xffff0000, v45
    v_add_f32 v26, v26, v50
    v_add_f32 v27, v27, v51
    v_lshlrev_b32 v48, 16, v46
    v_and_b32 v49, 0xffff0000, v46
    v_add_f32 v28, v28, v48
    v_add_f32 v29, v29, v49
    v_lshlrev_b32 v50, 16, v47
    v_and_b32 v51, 0xffff0000, v47
    v_add_f32 v30, v30, v50
    v_add_f32 v31, v31, v51
    s_waitcnt vmcnt(12) lgkmcnt(0)
    s_barrier
    ds_read_b128 v[40:43], v21 offset:24576
    ds_read_b128 v[44:47], v21 offset:25600
    s_add_u32 m0, s57, 49152
    s_mov_b32 s33, 688128
    buffer_load_dwordx4 v11, s[40:43], s33 offen lds
    s_add_u32 m0, s57, 50176
    s_mov_b32 s33, 716800
    buffer_load_dwordx4 v11, s[40:43], s33 offen lds
    s_add_u32 m0, s56, 49152
    s_mov_b32 s33, 384
    buffer_load_dwordx4 v10, s[36:39], s33 offen lds
    s_add_u32 m0, s56, 50176
    s_mov_b32 s33, 14720
    buffer_load_dwordx4 v10, s[36:39], s33 offen lds
    s_add_u32 m0, s56, 51200
    s_mov_b32 s33, 29056
    buffer_load_dwordx4 v10, s[36:39], s33 offen lds
    s_add_u32 m0, s56, 52224
    s_mov_b32 s33, 43392
    buffer_load_dwordx4 v10, s[36:39], s33 offen lds
    v_lshlrev_b32 v48, 16, v32
    v_and_b32 v49, 0xffff0000, v32
    v_add_f32 v24, v24, v48
    v_add_f32 v25, v25, v49
    v_lshlrev_b32 v50, 16, v33
    v_and_b32 v51, 0xffff0000, v33
    v_add_f32 v26, v26, v50
    v_add_f32 v27, v27, v51
    v_lshlrev_b32 v48, 16, v34
    v_and_b32 v49, 0xffff0000, v34
    v_add_f32 v28, v28, v48
    v_add_f32 v29, v29, v49
    v_lshlrev_b32 v50, 16, v35
    v_and_b32 v51, 0xffff0000, v35
    v_add_f32 v30, v30, v50
    v_add_f32 v31, v31, v51
    v_lshlrev_b32 v48, 16, v36
    v_and_b32 v49, 0xffff0000, v36
    v_add_f32 v24, v24, v48
    v_add_f32 v25, v25, v49
    v_lshlrev_b32 v50, 16, v37
    v_and_b32 v51, 0xffff0000, v37
    v_add_f32 v26, v26, v50
    v_add_f32 v27, v27, v51
    v_lshlrev_b32 v48, 16, v38
    v_and_b32 v49, 0xffff0000, v38
    v_add_f32 v28, v28, v48
    v_add_f32 v29, v29, v49
    v_lshlrev_b32 v50, 16, v39
    v_and_b32 v51, 0xffff0000, v39
    v_add_f32 v30, v30, v50
    v_add_f32 v31, v31, v51
    s_waitcnt vmcnt(12) lgkmcnt(0)
    s_barrier
    ds_read_b128 v[32:35], v20 offset:0
    ds_read_b128 v[36:39], v20 offset:1024
    s_add_u32 m0, s57, 73728
    s_mov_b32 s33, 802816
    buffer_load_dwordx4 v11, s[40:43], s33 offen lds
    s_add_u32 m0, s57, 74752
    s_mov_b32 s33, 831488
    buffer_load_dwordx4 v11, s[40:43], s33 offen lds
    s_add_u32 m0, s56, 73728
    s_mov_b32 s33, 448
    buffer_load_dwordx4 v10, s[36:39], s33 offen lds
    s_add_u32 m0, s56, 74752
    s_mov_b32 s33, 14784
    buffer_load_dwordx4 v10, s[36:39], s33 offen lds
    s_add_u32 m0, s56, 75776
    s_mov_b32 s33, 29120
    buffer_load_dwordx4 v10, s[36:39], s33 offen lds
    s_add_u32 m0, s56, 76800
    s_mov_b32 s33, 43456
    buffer_load_dwordx4 v10, s[36:39], s33 offen lds
    v_lshlrev_b32 v48, 16, v40
    v_and_b32 v49, 0xffff0000, v40
    v_add_f32 v24, v24, v48
    v_add_f32 v25, v25, v49
    v_lshlrev_b32 v50, 16, v41
    v_and_b32 v51, 0xffff0000, v41
    v_add_f32 v26, v26, v50
    v_add_f32 v27, v27, v51
    v_lshlrev_b32 v48, 16, v42
    v_and_b32 v49, 0xffff0000, v42
    v_add_f32 v28, v28, v48
    v_add_f32 v29, v29, v49
    v_lshlrev_b32 v50, 16, v43
    v_and_b32 v51, 0xffff0000, v43
    v_add_f32 v30, v30, v50
    v_add_f32 v31, v31, v51
    v_lshlrev_b32 v48, 16, v44
    v_and_b32 v49, 0xffff0000, v44
    v_add_f32 v24, v24, v48
    v_add_f32 v25, v25, v49
    v_lshlrev_b32 v50, 16, v45
    v_and_b32 v51, 0xffff0000, v45
    v_add_f32 v26, v26, v50
    v_add_f32 v27, v27, v51
    v_lshlrev_b32 v48, 16, v46
    v_and_b32 v49, 0xffff0000, v46
    v_add_f32 v28, v28, v48
    v_add_f32 v29, v29, v49
    v_lshlrev_b32 v50, 16, v47
    v_and_b32 v51, 0xffff0000, v47
    v_add_f32 v30, v30, v50
    v_add_f32 v31, v31, v51
    s_waitcnt vmcnt(12) lgkmcnt(0)
    s_barrier
    ds_read_b128 v[40:43], v20 offset:24576
    ds_read_b128 v[44:47], v20 offset:25600
    s_add_u32 m0, s57, 0
    s_mov_b32 s33, 917504
    buffer_load_dwordx4 v11, s[40:43], s33 offen lds
    s_add_u32 m0, s57, 1024
    s_mov_b32 s33, 946176
    buffer_load_dwordx4 v11, s[40:43], s33 offen lds
    s_add_u32 m0, s56, 0
    s_mov_b32 s33, 512
    buffer_load_dwordx4 v10, s[36:39], s33 offen lds
    s_add_u32 m0, s56, 1024
    s_mov_b32 s33, 14848
    buffer_load_dwordx4 v10, s[36:39], s33 offen lds
    s_add_u32 m0, s56, 2048
    s_mov_b32 s33, 29184
    buffer_load_dwordx4 v10, s[36:39], s33 offen lds
    s_add_u32 m0, s56, 3072
    s_mov_b32 s33, 43520
    buffer_load_dwordx4 v10, s[36:39], s33 offen lds
    v_lshlrev_b32 v48, 16, v32
    v_and_b32 v49, 0xffff0000, v32
    v_add_f32 v24, v24, v48
    v_add_f32 v25, v25, v49
    v_lshlrev_b32 v50, 16, v33
    v_and_b32 v51, 0xffff0000, v33
    v_add_f32 v26, v26, v50
    v_add_f32 v27, v27, v51
    v_lshlrev_b32 v48, 16, v34
    v_and_b32 v49, 0xffff0000, v34
    v_add_f32 v28, v28, v48
    v_add_f32 v29, v29, v49
    v_lshlrev_b32 v50, 16, v35
    v_and_b32 v51, 0xffff0000, v35
    v_add_f32 v30, v30, v50
    v_add_f32 v31, v31, v51
    v_lshlrev_b32 v48, 16, v36
    v_and_b32 v49, 0xffff0000, v36
    v_add_f32 v24, v24, v48
    v_add_f32 v25, v25, v49
    v_lshlrev_b32 v50, 16, v37
    v_and_b32 v51, 0xffff0000, v37
    v_add_f32 v26, v26, v50
    v_add_f32 v27, v27, v51
    v_lshlrev_b32 v48, 16, v38
    v_and_b32 v49, 0xffff0000, v38
    v_add_f32 v28, v28, v48
    v_add_f32 v29, v29, v49
    v_lshlrev_b32 v50, 16, v39
    v_and_b32 v51, 0xffff0000, v39
    v_add_f32 v30, v30, v50
    v_add_f32 v31, v31, v51
    s_waitcnt vmcnt(12) lgkmcnt(0)
    s_barrier
    ds_read_b128 v[32:35], v21 offset:0
    ds_read_b128 v[36:39], v21 offset:1024
    s_add_u32 m0, s57, 24576
    s_mov_b32 s33, 1032192
    buffer_load_dwordx4 v11, s[40:43], s33 offen lds
    s_add_u32 m0, s57, 25600
    s_mov_b32 s33, 1060864
    buffer_load_dwordx4 v11, s[40:43], s33 offen lds
    s_add_u32 m0, s56, 24576
    s_mov_b32 s33, 576
    buffer_load_dwordx4 v10, s[36:39], s33 offen lds
    s_add_u32 m0, s56, 25600
    s_mov_b32 s33, 14912
    buffer_load_dwordx4 v10, s[36:39], s33 offen lds
    s_add_u32 m0, s56, 26624
    s_mov_b32 s33, 29248
    buffer_load_dwordx4 v10, s[36:39], s33 offen lds
    s_add_u32 m0, s56, 27648
    s_mov_b32 s33, 43584
    buffer_load_dwordx4 v10, s[36:39], s33 offen lds
    v_lshlrev_b32 v48, 16, v40
    v_and_b32 v49, 0xffff0000, v40
    v_add_f32 v24, v24, v48
    v_add_f32 v25, v25, v49
    v_lshlrev_b32 v50, 16, v41
    v_and_b32 v51, 0xffff0000, v41
    v_add_f32 v26, v26, v50
    v_add_f32 v27, v27, v51
    v_lshlrev_b32 v48, 16, v42
    v_and_b32 v49, 0xffff0000, v42
    v_add_f32 v28, v28, v48
    v_add_f32 v29, v29, v49
    v_lshlrev_b32 v50, 16, v43
    v_and_b32 v51, 0xffff0000, v43
    v_add_f32 v30, v30, v50
    v_add_f32 v31, v31, v51
    v_lshlrev_b32 v48, 16, v44
    v_and_b32 v49, 0xffff0000, v44
    v_add_f32 v24, v24, v48
    v_add_f32 v25, v25, v49
    v_lshlrev_b32 v50, 16, v45
    v_and_b32 v51, 0xffff0000, v45
    v_add_f32 v26, v26, v50
    v_add_f32 v27, v27, v51
    v_lshlrev_b32 v48, 16, v46
    v_and_b32 v49, 0xffff0000, v46
    v_add_f32 v28, v28, v48
    v_add_f32 v29, v29, v49
    v_lshlrev_b32 v50, 16, v47
    v_and_b32 v51, 0xffff0000, v47
    v_add_f32 v30, v30, v50
    v_add_f32 v31, v31, v51
    s_waitcnt vmcnt(12) lgkmcnt(0)
    s_barrier
    ds_read_b128 v[40:43], v21 offset:24576
    ds_read_b128 v[44:47], v21 offset:25600
    s_add_u32 m0, s57, 49152
    s_mov_b32 s33, 1146880
    buffer_load_dwordx4 v11, s[40:43], s33 offen lds
    s_add_u32 m0, s57, 50176
    s_mov_b32 s33, 1175552
    buffer_load_dwordx4 v11, s[40:43], s33 offen lds
    s_add_u32 m0, s56, 49152
    s_mov_b32 s33, 640
    buffer_load_dwordx4 v10, s[36:39], s33 offen lds
    s_add_u32 m0, s56, 50176
    s_mov_b32 s33, 14976
    buffer_load_dwordx4 v10, s[36:39], s33 offen lds
    s_add_u32 m0, s56, 51200
    s_mov_b32 s33, 29312
    buffer_load_dwordx4 v10, s[36:39], s33 offen lds
    s_add_u32 m0, s56, 52224
    s_mov_b32 s33, 43648
    buffer_load_dwordx4 v10, s[36:39], s33 offen lds
    v_lshlrev_b32 v48, 16, v32
    v_and_b32 v49, 0xffff0000, v32
    v_add_f32 v24, v24, v48
    v_add_f32 v25, v25, v49
    v_lshlrev_b32 v50, 16, v33
    v_and_b32 v51, 0xffff0000, v33
    v_add_f32 v26, v26, v50
    v_add_f32 v27, v27, v51
    v_lshlrev_b32 v48, 16, v34
    v_and_b32 v49, 0xffff0000, v34
    v_add_f32 v28, v28, v48
    v_add_f32 v29, v29, v49
    v_lshlrev_b32 v50, 16, v35
    v_and_b32 v51, 0xffff0000, v35
    v_add_f32 v30, v30, v50
    v_add_f32 v31, v31, v51
    v_lshlrev_b32 v48, 16, v36
    v_and_b32 v49, 0xffff0000, v36
    v_add_f32 v24, v24, v48
    v_add_f32 v25, v25, v49
    v_lshlrev_b32 v50, 16, v37
    v_and_b32 v51, 0xffff0000, v37
    v_add_f32 v26, v26, v50
    v_add_f32 v27, v27, v51
    v_lshlrev_b32 v48, 16, v38
    v_and_b32 v49, 0xffff0000, v38
    v_add_f32 v28, v28, v48
    v_add_f32 v29, v29, v49
    v_lshlrev_b32 v50, 16, v39
    v_and_b32 v51, 0xffff0000, v39
    v_add_f32 v30, v30, v50
    v_add_f32 v31, v31, v51
    s_waitcnt vmcnt(12) lgkmcnt(0)
    s_barrier
    ds_read_b128 v[32:35], v20 offset:0
    ds_read_b128 v[36:39], v20 offset:1024
    s_add_u32 m0, s57, 73728
    s_mov_b32 s33, 1261568
    buffer_load_dwordx4 v11, s[40:43], s33 offen lds
    s_add_u32 m0, s57, 74752
    s_mov_b32 s33, 1290240
    buffer_load_dwordx4 v11, s[40:43], s33 offen lds
    s_add_u32 m0, s56, 73728
    s_mov_b32 s33, 704
    buffer_load_dwordx4 v10, s[36:39], s33 offen lds
    s_add_u32 m0, s56, 74752
    s_mov_b32 s33, 15040
    buffer_load_dwordx4 v10, s[36:39], s33 offen lds
    s_add_u32 m0, s56, 75776
    s_mov_b32 s33, 29376
    buffer_load_dwordx4 v10, s[36:39], s33 offen lds
    s_add_u32 m0, s56, 76800
    s_mov_b32 s33, 43712
    buffer_load_dwordx4 v10, s[36:39], s33 offen lds
    v_lshlrev_b32 v48, 16, v40
    v_and_b32 v49, 0xffff0000, v40
    v_add_f32 v24, v24, v48
    v_add_f32 v25, v25, v49
    v_lshlrev_b32 v50, 16, v41
    v_and_b32 v51, 0xffff0000, v41
    v_add_f32 v26, v26, v50
    v_add_f32 v27, v27, v51
    v_lshlrev_b32 v48, 16, v42
    v_and_b32 v49, 0xffff0000, v42
    v_add_f32 v28, v28, v48
    v_add_f32 v29, v29, v49
    v_lshlrev_b32 v50, 16, v43
    v_and_b32 v51, 0xffff0000, v43
    v_add_f32 v30, v30, v50
    v_add_f32 v31, v31, v51
    v_lshlrev_b32 v48, 16, v44
    v_and_b32 v49, 0xffff0000, v44
    v_add_f32 v24, v24, v48
    v_add_f32 v25, v25, v49
    v_lshlrev_b32 v50, 16, v45
    v_and_b32 v51, 0xffff0000, v45
    v_add_f32 v26, v26, v50
    v_add_f32 v27, v27, v51
    v_lshlrev_b32 v48, 16, v46
    v_and_b32 v49, 0xffff0000, v46
    v_add_f32 v28, v28, v48
    v_add_f32 v29, v29, v49
    v_lshlrev_b32 v50, 16, v47
    v_and_b32 v51, 0xffff0000, v47
    v_add_f32 v30, v30, v50
    v_add_f32 v31, v31, v51
    s_waitcnt vmcnt(12) lgkmcnt(0)
    s_barrier
    ds_read_b128 v[40:43], v20 offset:24576
    ds_read_b128 v[44:47], v20 offset:25600
    s_add_u32 m0, s57, 0
    s_mov_b32 s33, 1376256
    buffer_load_dwordx4 v11, s[40:43], s33 offen lds
    s_add_u32 m0, s57, 1024
    s_mov_b32 s33, 1404928
    buffer_load_dwordx4 v11, s[40:43], s33 offen lds
    s_add_u32 m0, s56, 0
    s_mov_b32 s33, 768
    buffer_load_dwordx4 v10, s[36:39], s33 offen lds
    s_add_u32 m0, s56, 1024
    s_mov_b32 s33, 15104
    buffer_load_dwordx4 v10, s[36:39], s33 offen lds
    s_add_u32 m0, s56, 2048
    s_mov_b32 s33, 29440
    buffer_load_dwordx4 v10, s[36:39], s33 offen lds
    s_add_u32 m0, s56, 3072
    s_mov_b32 s33, 43776
    buffer_load_dwordx4 v10, s[36:39], s33 offen lds
    v_lshlrev_b32 v48, 16, v32
    v_and_b32 v49, 0xffff0000, v32
    v_add_f32 v24, v24, v48
    v_add_f32 v25, v25, v49
    v_lshlrev_b32 v50, 16, v33
    v_and_b32 v51, 0xffff0000, v33
    v_add_f32 v26, v26, v50
    v_add_f32 v27, v27, v51
    v_lshlrev_b32 v48, 16, v34
    v_and_b32 v49, 0xffff0000, v34
    v_add_f32 v28, v28, v48
    v_add_f32 v29, v29, v49
    v_lshlrev_b32 v50, 16, v35
    v_and_b32 v51, 0xffff0000, v35
    v_add_f32 v30, v30, v50
    v_add_f32 v31, v31, v51
    v_lshlrev_b32 v48, 16, v36
    v_and_b32 v49, 0xffff0000, v36
    v_add_f32 v24, v24, v48
    v_add_f32 v25, v25, v49
    v_lshlrev_b32 v50, 16, v37
    v_and_b32 v51, 0xffff0000, v37
    v_add_f32 v26, v26, v50
    v_add_f32 v27, v27, v51
    v_lshlrev_b32 v48, 16, v38
    v_and_b32 v49, 0xffff0000, v38
    v_add_f32 v28, v28, v48
    v_add_f32 v29, v29, v49
    v_lshlrev_b32 v50, 16, v39
    v_and_b32 v51, 0xffff0000, v39
    v_add_f32 v30, v30, v50
    v_add_f32 v31, v31, v51
    s_waitcnt vmcnt(12) lgkmcnt(0)
    s_barrier
    ds_read_b128 v[32:35], v21 offset:0
    ds_read_b128 v[36:39], v21 offset:1024
    s_add_u32 m0, s57, 24576
    s_mov_b32 s33, 1490944
    buffer_load_dwordx4 v11, s[40:43], s33 offen lds
    s_add_u32 m0, s57, 25600
    s_mov_b32 s33, 1519616
    buffer_load_dwordx4 v11, s[40:43], s33 offen lds
    s_add_u32 m0, s56, 24576
    s_mov_b32 s33, 832
    buffer_load_dwordx4 v10, s[36:39], s33 offen lds
    s_add_u32 m0, s56, 25600
    s_mov_b32 s33, 15168
    buffer_load_dwordx4 v10, s[36:39], s33 offen lds
    s_add_u32 m0, s56, 26624
    s_mov_b32 s33, 29504
    buffer_load_dwordx4 v10, s[36:39], s33 offen lds
    s_add_u32 m0, s56, 27648
    s_mov_b32 s33, 43840
    buffer_load_dwordx4 v10, s[36:39], s33 offen lds
    v_lshlrev_b32 v48, 16, v40
    v_and_b32 v49, 0xffff0000, v40
    v_add_f32 v24, v24, v48
    v_add_f32 v25, v25, v49
    v_lshlrev_b32 v50, 16, v41
    v_and_b32 v51, 0xffff0000, v41
    v_add_f32 v26, v26, v50
    v_add_f32 v27, v27, v51
    v_lshlrev_b32 v48, 16, v42
    v_and_b32 v49, 0xffff0000, v42
    v_add_f32 v28, v28, v48
    v_add_f32 v29, v29, v49
    v_lshlrev_b32 v50, 16, v43
    v_and_b32 v51, 0xffff0000, v43
    v_add_f32 v30, v30, v50
    v_add_f32 v31, v31, v51
    v_lshlrev_b32 v48, 16, v44
    v_and_b32 v49, 0xffff0000, v44
    v_add_f32 v24, v24, v48
    v_add_f32 v25, v25, v49
    v_lshlrev_b32 v50, 16, v45
    v_and_b32 v51, 0xffff0000, v45
    v_add_f32 v26, v26, v50
    v_add_f32 v27, v27, v51
    v_lshlrev_b32 v48, 16, v46
    v_and_b32 v49, 0xffff0000, v46
    v_add_f32 v28, v28, v48
    v_add_f32 v29, v29, v49
    v_lshlrev_b32 v50, 16, v47
    v_and_b32 v51, 0xffff0000, v47
    v_add_f32 v30, v30, v50
    v_add_f32 v31, v31, v51
    s_waitcnt vmcnt(12) lgkmcnt(0)
    s_barrier
    ds_read_b128 v[40:43], v21 offset:24576
    ds_read_b128 v[44:47], v21 offset:25600
    s_lshl_b32 s35, s2, 9
    s_add_u32 s35, s35, 9240832
    v_and_b32 v17, 31, v1
    v_lshlrev_b32 v17, 2, v17
    buffer_load_dwordx4 v[104:107], v12, s[44:47], 0 offen
    buffer_load_dwordx2 v[108:109], v13, s[44:47], 0 offen
    buffer_load_dwordx4 v[112:115], v14, s[44:47], 0 offen offset:0
    buffer_load_dwordx2 v[116:117], v14, s[44:47], 0 offen offset:16
    buffer_load_dwordx4 v[120:123], v14, s[44:47], 0 offen offset:1024
    buffer_load_dwordx2 v[124:125], v14, s[44:47], 0 offen offset:1040
    buffer_load_dwordx4 v[128:131], v14, s[44:47], 0 offen offset:2048
    buffer_load_dwordx2 v[132:133], v14, s[44:47], 0 offen offset:2064
    buffer_load_dwordx4 v[136:139], v14, s[44:47], 0 offen offset:2080
    buffer_load_dwordx2 v[140:141], v14, s[44:47], 0 offen offset:2096
    s_mov_b32 s36, s20
    s_and_b32 s37, s21, 0xffff
    s_mov_b32 s38, 1605632
    s_mov_b32 s39, 0x00020000
    s_mul_i32 s33, s2, 7168
    s_lshl_b32 s34, s54, 11
    s_add_u32 s33, s33, s34
    buffer_load_dwordx4 v[52:55], v9, s[36:39], s33 offen
    buffer_load_dwordx4 v[52:55], v9, s[36:39], s33 offen offset:1024
    v_lshlrev_b32 v48, 16, v32
    v_and_b32 v49, 0xffff0000, v32
    v_add_f32 v24, v24, v48
    v_add_f32 v25, v25, v49
    v_lshlrev_b32 v50, 16, v33
    v_and_b32 v51, 0xffff0000, v33
    v_add_f32 v26, v26, v50
    v_add_f32 v27, v27, v51
    v_lshlrev_b32 v48, 16, v34
    v_and_b32 v49, 0xffff0000, v34
    v_add_f32 v28, v28, v48
    v_add_f32 v29, v29, v49
    v_lshlrev_b32 v50, 16, v35
    v_and_b32 v51, 0xffff0000, v35
    v_add_f32 v30, v30, v50
    v_add_f32 v31, v31, v51
    v_lshlrev_b32 v48, 16, v36
    v_and_b32 v49, 0xffff0000, v36
    v_add_f32 v24, v24, v48
    v_add_f32 v25, v25, v49
    v_lshlrev_b32 v50, 16, v37
    v_and_b32 v51, 0xffff0000, v37
    v_add_f32 v26, v26, v50
    v_add_f32 v27, v27, v51
    v_lshlrev_b32 v48, 16, v38
    v_and_b32 v49, 0xffff0000, v38
    v_add_f32 v28, v28, v48
    v_add_f32 v29, v29, v49
    v_lshlrev_b32 v50, 16, v39
    v_and_b32 v51, 0xffff0000, v39
    v_add_f32 v30, v30, v50
    v_add_f32 v31, v31, v51
    s_waitcnt vmcnt(18) lgkmcnt(0)
    s_barrier
    ds_read_b128 v[32:35], v20 offset:0
    ds_read_b128 v[36:39], v20 offset:1024
    v_lshlrev_b32 v48, 16, v40
    v_and_b32 v49, 0xffff0000, v40
    v_add_f32 v24, v24, v48
    v_add_f32 v25, v25, v49
    v_lshlrev_b32 v50, 16, v41
    v_and_b32 v51, 0xffff0000, v41
    v_add_f32 v26, v26, v50
    v_add_f32 v27, v27, v51
    v_lshlrev_b32 v48, 16, v42
    v_and_b32 v49, 0xffff0000, v42
    v_add_f32 v28, v28, v48
    v_add_f32 v29, v29, v49
    v_lshlrev_b32 v50, 16, v43
    v_and_b32 v51, 0xffff0000, v43
    v_add_f32 v30, v30, v50
    v_add_f32 v31, v31, v51
    v_lshlrev_b32 v48, 16, v44
    v_and_b32 v49, 0xffff0000, v44
    v_add_f32 v24, v24, v48
    v_add_f32 v25, v25, v49
    v_lshlrev_b32 v50, 16, v45
    v_and_b32 v51, 0xffff0000, v45
    v_add_f32 v26, v26, v50
    v_add_f32 v27, v27, v51
    v_lshlrev_b32 v48, 16, v46
    v_and_b32 v49, 0xffff0000, v46
    v_add_f32 v28, v28, v48
    v_add_f32 v29, v29, v49
    v_lshlrev_b32 v50, 16, v47
    v_and_b32 v51, 0xffff0000, v47
    v_add_f32 v30, v30, v50
    v_add_f32 v31, v31, v51
    s_waitcnt vmcnt(12) lgkmcnt(0)
    s_barrier
    ds_read_b128 v[40:43], v20 offset:24576
    ds_read_b128 v[44:47], v20 offset:25600
    buffer_load_dword v16, v17, s[28:31], s35 offen sc1
    v_lshlrev_b32 v48, 16, v32
    v_and_b32 v49, 0xffff0000, v32
    v_add_f32 v24, v24, v48
    v_add_f32 v25, v25, v49
    v_lshlrev_b32 v50, 16, v33
    v_and_b32 v51, 0xffff0000, v33
    v_add_f32 v26, v26, v50
    v_add_f32 v27, v27, v51
    v_lshlrev_b32 v48, 16, v34
    v_and_b32 v49, 0xffff0000, v34
    v_add_f32 v28, v28, v48
    v_add_f32 v29, v29, v49
    v_lshlrev_b32 v50, 16, v35
    v_and_b32 v51, 0xffff0000, v35
    v_add_f32 v30, v30, v50
    v_add_f32 v31, v31, v51
    v_lshlrev_b32 v48, 16, v36
    v_and_b32 v49, 0xffff0000, v36
    v_add_f32 v24, v24, v48
    v_add_f32 v25, v25, v49
    v_lshlrev_b32 v50, 16, v37
    v_and_b32 v51, 0xffff0000, v37
    v_add_f32 v26, v26, v50
    v_add_f32 v27, v27, v51
    v_lshlrev_b32 v48, 16, v38
    v_and_b32 v49, 0xffff0000, v38
    v_add_f32 v28, v28, v48
    v_add_f32 v29, v29, v49
    v_lshlrev_b32 v50, 16, v39
    v_and_b32 v51, 0xffff0000, v39
    v_add_f32 v30, v30, v50
    v_add_f32 v31, v31, v51
    s_waitcnt lgkmcnt(0)
    v_lshlrev_b32 v48, 16, v40
    v_and_b32 v49, 0xffff0000, v40
    v_add_f32 v24, v24, v48
    v_add_f32 v25, v25, v49
    v_lshlrev_b32 v50, 16, v41
    v_and_b32 v51, 0xffff0000, v41
    v_add_f32 v26, v26, v50
    v_add_f32 v27, v27, v51
    v_lshlrev_b32 v48, 16, v42
    v_and_b32 v49, 0xffff0000, v42
    v_add_f32 v28, v28, v48
    v_add_f32 v29, v29, v49
    v_lshlrev_b32 v50, 16, v43
    v_and_b32 v51, 0xffff0000, v43
    v_add_f32 v30, v30, v50
    v_add_f32 v31, v31, v51
    v_lshlrev_b32 v48, 16, v44
    v_and_b32 v49, 0xffff0000, v44
    v_add_f32 v24, v24, v48
    v_add_f32 v25, v25, v49
    v_lshlrev_b32 v50, 16, v45
    v_and_b32 v51, 0xffff0000, v45
    v_add_f32 v26, v26, v50
    v_add_f32 v27, v27, v51
    v_lshlrev_b32 v48, 16, v46
    v_and_b32 v49, 0xffff0000, v46
    v_add_f32 v28, v28, v48
    v_add_f32 v29, v29, v49
    v_lshlrev_b32 v50, 16, v47
    v_and_b32 v51, 0xffff0000, v47
    v_add_f32 v30, v30, v50
    v_add_f32 v31, v31, v51
    v_and_b32 v2, 8, v1
    v_cmp_ne_u32 vcc, 0, v2
    s_nop 1
    v_cndmask_b32 v32, v24, v28, vcc
    v_cndmask_b32 v36, v28, v24, vcc
    v_cndmask_b32 v33, v25, v29, vcc
    v_cndmask_b32 v37, v29, v25, vcc
    v_cndmask_b32 v34, v26, v30, vcc
    v_cndmask_b32 v38, v30, v26, vcc
    v_cndmask_b32 v35, v27, v31, vcc
    v_cndmask_b32 v39, v31, v27, vcc
    s_nop 1
    v_add_f32_dpp v24, v36, v32 row_ror:8 row_mask:0xf bank_mask:0xf
    v_add_f32_dpp v25, v37, v33 row_ror:8 row_mask:0xf bank_mask:0xf
    v_add_f32_dpp v26, v38, v34 row_ror:8 row_mask:0xf bank_mask:0xf
    v_add_f32_dpp v27, v39, v35 row_ror:8 row_mask:0xf bank_mask:0xf
    s_nop 1
    v_permlane16_swap_b32 v24, v26
    v_permlane16_swap_b32 v25, v27
    s_nop 1
    v_add_f32 v24, v24, v26
    v_add_f32 v25, v25, v27
    s_nop 1
    v_permlane32_swap_b32 v24, v25
    s_nop 1
    v_add_f32 v24, v24, v25
    v_cvt_pk_bf16_f32 v26, v24, v24
    v_lshlrev_b32 v27, 16, v26
    v_sub_f32 v24, v24, v27
    v_cvt_pk_bf16_f32 v28, v24, v24
    v_lshlrev_b32 v27, 16, v28
    v_sub_f32 v24, v24, v27
    v_cvt_pk_bf16_f32 v29, v24, v24
    v_and_b32 v2, 7, v1
    v_bfe_u32 v3, v1, 3, 1
    v_lshlrev_b32 v2, 3, v2
    v_lshl_add_u32 v2, v3, 2, v2
    v_bfe_u32 v3, v1, 4, 1
    v_lshl_add_u32 v2, v3, 1, v2
    v_lshrrev_b32 v3, 5, v1
    v_add_u32 v2, v2, v3
    s_lshl_b32 s33, s55, 10
    s_add_u32 s33, s33, 142848
    v_lshl_add_u32 v2, v2, 4, s33
    s_and_b32 s34, s54, 1
    s_cmp_eq_u32 s34, 1
    s_cbranch_scc1 k_csh_24
    v_and_b32 v26, 0xffff, v26
    v_lshl_or_b32 v26, v28, 16, v26
    ds_write_b32 v2, v26
    ds_write_b16 v2, v29 offset:4
    s_branch k_csj_25
k_csh_24:
    v_and_b32 v28, 0xffff, v28
    v_lshl_or_b32 v28, v29, 16, v28
    v_mov_b32 v29, 0
    ds_write_b16 v2, v26 offset:6
    ds_write_b64 v2, v[28:29] offset:8
k_csj_25:
    s_waitcnt lgkmcnt(0)
    s_barrier
    s_setprio 1
    s_waitcnt vmcnt(0)
    v_cmp_ne_u32 vcc, 1, v16
    s_mov_b32 s56, 0
    s_nop 2
    s_cmp_lg_u64 vcc, 0
    s_cbranch_scc1 k_urs_27
    s_add_u32 s33, s59, 7340032
    s_add_u32 s44, s26, s33
    s_addc_u32 s45, s27, 0
    s_and_b32 s45, s45, 0xffff
    s_movk_i32 s46, 4096
    s_mov_b32 s47, 0x00020000
    s_add_u32 m0, s94, 0
    s_movk_i32 s33, 0
    buffer_load_dwordx4 v9, s[44:47], s33 offen sc1 lds
    s_add_u32 m0, s94, 1024
    s_movk_i32 s33, 1024
    buffer_load_dwordx4 v9, s[44:47], s33 offen sc1 lds
    s_add_u32 m0, s94, 2048
    s_movk_i32 s33, 2048
    buffer_load_dwordx4 v9, s[44:47], s33 offen sc1 lds
    s_add_u32 m0, s94, 3072
    s_movk_i32 s33, 3072
    buffer_load_dwordx4 v9, s[44:47], s33 offen sc1 lds
    s_add_u32 m0, s94, 4096
    s_movk_i32 s33, 4096
    buffer_load_dwordx4 v9, s[44:47], s33 offen sc1 lds
    s_mov_b32 s56, 1
    v_mov_b32 v2, 1
    v_mov_b32 v3, 153604
    s_mov_b64 exec, 1
    ds_add_u32 v3, v2
    s_mov_b64 exec, -1
k_urs_27:
    s_cmp_eq_u32 s56, 1
    s_cbranch_scc1 k_kw_26
    buffer_load_dword v16, v17, s[28:31], s35 offen sc1
    s_waitcnt vmcnt(1)
k_kw_26:
    s_waitcnt vmcnt(5)
    s_and_b32 s34, s54, 1
    ds_write_b128 v15, v[104:107] offset:0
    v_alignbit_b32 v144, v105, v104, 16
    v_alignbit_b32 v145, v106, v105, 16
    v_alignbit_b32 v146, v107, v106, 16
    v_alignbit_b32 v147, v108, v107, 16
    v_mov_b32 v148, v105
    v_mov_b32 v149, v106
    v_mov_b32 v150, v107
    v_mov_b32 v151, v108
    v_alignbit_b32 v152, v106, v105, 16
    v_alignbit_b32 v153, v107, v106, 16
    v_alignbit_b32 v154, v108, v107, 16
    v_alignbit_b32 v155, v109, v108, 16
    ds_write_b128 v15, v[144:147] offset:4160
    ds_write_b128 v15, v[148:151] offset:8320
    ds_write_b128 v15, v[152:155] offset:12480
    s_waitcnt lgkmcnt(4)
    ds_write_b128 v15, v[112:115] offset:1024
    v_alignbit_b32 v156, v113, v112, 16
    v_alignbit_b32 v157, v114, v113, 16
    v_alignbit_b32 v158, v115, v114, 16
    v_alignbit_b32 v159, v116, v115, 16
    v_mov_b32 v160, v113
    v_mov_b32 v161, v114
    v_mov_b32 v162, v115
    v_mov_b32 v163, v116
    v_alignbit_b32 v164, v114, v113, 16
    v_alignbit_b32 v165, v115, v114, 16
    v_alignbit_b32 v166, v116, v115, 16
    v_alignbit_b32 v167, v117, v116, 16
    ds_write_b128 v15, v[156:159] offset:5184
    ds_write_b128 v15, v[160:163] offset:9344
    ds_write_b128 v15, v[164:167] offset:13504
    s_cmp_eq_u32 s56, 1
    s_cbranch_scc1 k_mid_28
    s_waitcnt vmcnt(0)
    v_cmp_ne_u32 vcc, 1, v16
    s_mov_b32 s56, 0
    s_nop 2
    s_cmp_lg_u64 vcc, 0
    s_cbranch_scc1 k_urs_29
    s_add_u32 s33, s59, 7340032
    s_add_u32 s44, s26, s33
    s_addc_u32 s45, s27, 0
    s_and_b32 s45, s45, 0xffff
    s_movk_i32 s46, 4096
    s_mov_b32 s47, 0x00020000
    s_add_u32 m0, s94, 0
    s_movk_i32 s33, 0
    buffer_load_dwordx4 v9, s[44:47], s33 offen sc1 lds
    s_add_u32 m0, s94, 1024
    s_movk_i32 s33, 1024
    buffer_load_dwordx4 v9, s[44:47], s33 offen sc1 lds
    s_add_u32 m0, s94, 2048
    s_movk_i32 s33, 2048
    buffer_load_dwordx4 v9, s[44:47], s33 offen sc1 lds
    s_add_u32 m0, s94, 3072
    s_movk_i32 s33, 3072
    buffer_load_dwordx4 v9, s[44:47], s33 offen sc1 lds
    s_add_u32 m0, s94, 4096
    s_movk_i32 s33, 4096
    buffer_load_dwordx4 v9, s[44:47], s33 offen sc1 lds
    s_mov_b32 s56, 1
    v_mov_b32 v2, 1
    v_mov_b32 v3, 153604
    s_mov_b64 exec, 1
    ds_add_u32 v3, v2
    s_mov_b64 exec, -1
k_urs_29:
    s_cmp_eq_u32 s56, 1
    s_cbranch_scc1 k_mid_28
    buffer_load_dword v16, v17, s[28:31], s35 offen sc1
k_mid_28:
    s_waitcnt lgkmcnt(0)
    ds_write_b128 v15, v[120:123] offset:2048
    v_alignbit_b32 v144, v121, v120, 16
    v_alignbit_b32 v145, v122, v121, 16
    v_alignbit_b32 v146, v123, v122, 16
    v_alignbit_b32 v147, v124, v123, 16
    v_mov_b32 v148, v121
    v_mov_b32 v149, v122
    v_mov_b32 v150, v123
    v_mov_b32 v151, v124
    v_alignbit_b32 v152, v122, v121, 16
    v_alignbit_b32 v153, v123, v122, 16
    v_alignbit_b32 v154, v124, v123, 16
    v_alignbit_b32 v155, v125, v124, 16
    ds_write_b128 v15, v[144:147] offset:6208
    ds_write_b128 v15, v[148:151] offset:10368
    ds_write_b128 v15, v[152:155] offset:14528
    s_waitcnt lgkmcnt(4)
    ds_write_b128 v15, v[128:131] offset:3072
    v_alignbit_b32 v156, v129, v128, 16
    v_alignbit_b32 v157, v130, v129, 16
    v_alignbit_b32 v158, v131, v130, 16
    v_alignbit_b32 v159, v132, v131, 16
    v_mov_b32 v160, v129
    v_mov_b32 v161, v130
    v_mov_b32 v162, v131
    v_mov_b32 v163, v132
    v_alignbit_b32 v164, v130, v129, 16
    v_alignbit_b32 v165, v131, v130, 16
    v_alignbit_b32 v166, v132, v131, 16
    v_alignbit_b32 v167, v133, v132, 16
    ds_write_b128 v15, v[156:159] offset:7232
    ds_write_b128 v15, v[160:163] offset:11392
    ds_write_b128 v15, v[164:167] offset:15552
    s_cmp_eq_u32 s56, 1
    s_cbranch_scc1 k_mid_30
    s_waitcnt vmcnt(0)
    v_cmp_ne_u32 vcc, 1, v16
    s_mov_b32 s56, 0
    s_nop 2
    s_cmp_lg_u64 vcc, 0
    s_cbranch_scc1 k_urs_31
    s_add_u32 s33, s59, 7340032
    s_add_u32 s44, s26, s33
    s_addc_u32 s45, s27, 0
    s_and_b32 s45, s45, 0xffff
    s_movk_i32 s46, 4096
    s_mov_b32 s47, 0x00020000
    s_add_u32 m0, s94, 0
    s_movk_i32 s33, 0
    buffer_load_dwordx4 v9, s[44:47], s33 offen sc1 lds
    s_add_u32 m0, s94, 1024
    s_movk_i32 s33, 1024
    buffer_load_dwordx4 v9, s[44:47], s33 offen sc1 lds
    s_add_u32 m0, s94, 2048
    s_movk_i32 s33, 2048
    buffer_load_dwordx4 v9, s[44:47], s33 offen sc1 lds
    s_add_u32 m0, s94, 3072
    s_movk_i32 s33, 3072
    buffer_load_dwordx4 v9, s[44:47], s33 offen sc1 lds
    s_add_u32 m0, s94, 4096
    s_movk_i32 s33, 4096
    buffer_load_dwordx4 v9, s[44:47], s33 offen sc1 lds
    s_mov_b32 s56, 1
    v_mov_b32 v2, 1
    v_mov_b32 v3, 153604
    s_mov_b64 exec, 1
    ds_add_u32 v3, v2
    s_mov_b64 exec, -1
k_urs_31:
    s_cmp_eq_u32 s56, 1
    s_cbranch_scc1 k_mid_30
    buffer_load_dword v16, v17, s[28:31], s35 offen sc1
k_mid_30:
    s_waitcnt lgkmcnt(0)
    ds_write_b128 v15, v[136:139] offset:3104
    v_alignbit_b32 v144, v137, v136, 16
    v_alignbit_b32 v145, v138, v137, 16
    v_alignbit_b32 v146, v139, v138, 16
    v_alignbit_b32 v147, v140, v139, 16
    v_mov_b32 v148, v137
    v_mov_b32 v149, v138
    v_mov_b32 v150, v139
    v_mov_b32 v151, v140
    v_alignbit_b32 v152, v138, v137, 16
    v_alignbit_b32 v153, v139, v138, 16
    v_alignbit_b32 v154, v140, v139, 16
    v_alignbit_b32 v155, v141, v140, 16
    ds_write_b128 v15, v[144:147] offset:7264
    ds_write_b128 v15, v[148:151] offset:11424
    ds_write_b128 v15, v[152:155] offset:15584
k_ppl_32:
    s_cmp_eq_u32 s56, 1
    s_cbranch_scc1 k_ppk_33
    s_waitcnt vmcnt(0)
    v_cmp_ne_u32 vcc, 1, v16
    s_mov_b32 s56, 0
    s_nop 2
    s_cmp_lg_u64 vcc, 0
    s_cbranch_scc1 k_urs_34
    s_add_u32 s33, s59, 7340032
    s_add_u32 s44, s26, s33
    s_addc_u32 s45, s27, 0
    s_and_b32 s45, s45, 0xffff
    s_movk_i32 s46, 4096
    s_mov_b32 s47, 0x00020000
    s_add_u32 m0, s94, 0
    s_movk_i32 s33, 0
    buffer_load_dwordx4 v9, s[44:47], s33 offen sc1 lds
    s_add_u32 m0, s94, 1024
    s_movk_i32 s33, 1024
    buffer_load_dwordx4 v9, s[44:47], s33 offen sc1 lds
    s_add_u32 m0, s94, 2048
    s_movk_i32 s33, 2048
    buffer_load_dwordx4 v9, s[44:47], s33 offen sc1 lds
    s_add_u32 m0, s94, 3072
    s_movk_i32 s33, 3072
    buffer_load_dwordx4 v9, s[44:47], s33 offen sc1 lds
    s_add_u32 m0, s94, 4096
    s_movk_i32 s33, 4096
    buffer_load_dwordx4 v9, s[44:47], s33 offen sc1 lds
    s_mov_b32 s56, 1
    v_mov_b32 v2, 1
    v_mov_b32 v3, 153604
    s_mov_b64 exec, 1
    ds_add_u32 v3, v2
    s_mov_b64 exec, -1
k_urs_34:
    s_cmp_eq_u32 s56, 1
    s_cbranch_scc1 k_ppk_33
    s_sleep 4
    buffer_load_dword v16, v17, s[28:31], s35 offen sc1
    s_branch k_ppl_32
k_ppk_33:
    v_and_b32 v2, 15, v1
    v_lshrrev_b32 v3, 4, v1
    v_lshl_add_u32 v4, v3, 3, v2
    v_add_u32 v4, 1, v4
    v_and_b32 v5, 3, v4
    v_mul_u32_u24 v5, 4160, v5
    v_lshrrev_b32 v4, 2, v4
    v_lshl_add_u32 v5, v4, 3, v5
    v_add_u32 v22, s93, v5
    v_lshlrev_b32 v4, 5, v2
    v_sub_u32 v4, 480, v4
    v_lshl_add_u32 v4, v3, 4, v4
    v_add_u32 v23, s94, v4
    v_lshlrev_b32 v4, 5, v2
    v_lshl_add_u32 v8, v3, 3, v4
    v_sub_u32 v5, 504, v8
    v_add_u32 v19, s94, v5
    s_add_u32 s59, s59, 9437184
    s_cmp_eq_u32 s55, 0
    s_cselect_b32 s33, 16, 0
    s_lshl_b32 s95, s95, s33
    s_and_b32 s95, s95, 0xffff0000
    s_waitcnt vmcnt(0) lgkmcnt(0)
    s_and_b32 s33, s54, 1
    s_cmp_eq_u32 s33, 1
    s_cbranch_scc1 k_conv1
    ds_read_b64 v[40:41], v22 offset:0
    ds_read_b64 v[42:43], v22 offset:8
    ds_read_b128 v[72:75], v23 offset:3584
    ds_read_b64 v[44:45], v22 offset:512
    ds_read_b64 v[46:47], v22 offset:520
    ds_read_b128 v[76:79], v23 offset:3072
    ds_read_b64 v[48:49], v22 offset:1024
    ds_read_b64 v[50:51], v22 offset:1032
    ds_read_b128 v[80:83], v23 offset:2560
    ds_read_b64 v[52:53], v22 offset:1536
    ds_read_b64 v[54:55], v22 offset:1544
    ds_read_b128 v[84:87], v23 offset:2048
    ds_read_b64 v[56:57], v22 offset:2048
    ds_read_b64 v[58:59], v22 offset:2056
    ds_read_b128 v[88:91], v23 offset:1536
    ds_read_b64 v[60:61], v22 offset:2560
    ds_read_b64 v[62:63], v22 offset:2568
    ds_read_b128 v[92:95], v23 offset:1024
    ds_read_b64 v[64:65], v22 offset:3072
    ds_read_b64 v[66:67], v22 offset:3080
    ds_read_b128 v[96:99], v23 offset:512
    ds_read_b64 v[68:69], v22 offset:3584
    ds_read_b64 v[70:71], v22 offset:3592
    ds_read_b128 v[100:103], v23 offset:0
    s_waitcnt lgkmcnt(0)
    v_mfma_f32_16x16x32_bf16 v[24:27], v[40:43], v[72:75], 0
    ds_read_b64 v[104:105], v22 offset:64
    ds_read_b64 v[106:107], v22 offset:72
    v_mfma_f32_16x16x32_bf16 v[28:31], v[40:43], v[84:87], 0
    ds_read_b128 v[136:139], v23 offset:3648
    ds_read_b64 v[108:109], v22 offset:576
    v_mfma_f32_16x16x32_bf16 v[32:35], v[40:43], v[88:91], 0
    ds_read_b64 v[110:111], v22 offset:584
    ds_read_b128 v[140:143], v23 offset:3136
    v_mfma_f32_16x16x32_bf16 v[36:39], v[40:43], v[100:103], 0
    ds_read_b64 v[112:113], v22 offset:1088
    ds_read_b64 v[114:115], v22 offset:1096
    v_mfma_f32_16x16x32_bf16 v[28:31], v[44:47], v[80:83], v[28:31]
    ds_read_b128 v[144:147], v23 offset:2624
    ds_read_b64 v[116:117], v22 offset:1600
    v_mfma_f32_16x16x32_bf16 v[32:35], v[44:47], v[84:87], v[32:35]
    ds_read_b64 v[118:119], v22 offset:1608
    ds_read_b128 v[148:151], v23 offset:2112
    v_mfma_f32_16x16x32_bf16 v[36:39], v[44:47], v[96:99], v[36:39]
    ds_read_b64 v[120:121], v22 offset:2112
    ds_read_b64 v[122:123], v22 offset:2120
    v_mfma_f32_16x16x32_bf16 v[28:31], v[48:51], v[76:79], v[28:31]
    ds_read_b128 v[152:155], v23 offset:1600
    ds_read_b64 v[124:125], v22 offset:2624
    v_mfma_f32_16x16x32_bf16 v[32:35], v[48:51], v[80:83], v[32:35]
    ds_read_b64 v[126:127], v22 offset:2632
    ds_read_b128 v[156:159], v23 offset:1088
    v_mfma_f32_16x16x32_bf16 v[36:39], v[48:51], v[92:95], v[36:39]
    ds_read_b64 v[128:129], v22 offset:3136
    ds_read_b64 v[130:131], v22 offset:3144
    v_mfma_f32_16x16x32_bf16 v[28:31], v[52:55], v[72:75], v[28:31]
    ds_read_b128 v[160:163], v23 offset:576
    ds_read_b64 v[132:133], v22 offset:3648
    v_mfma_f32_16x16x32_bf16 v[32:35], v[52:55], v[76:79], v[32:35]
    ds_read_b64 v[134:135], v22 offset:3656
    ds_read_b128 v[164:167], v23 offset:64
    v_mfma_f32_16x16x32_bf16 v[36:39], v[52:55], v[88:91], v[36:39]
    v_mfma_f32_16x16x32_bf16 v[32:35], v[56:59], v[72:75], v[32:35]
    v_mfma_f32_16x16x32_bf16 v[36:39], v[56:59], v[84:87], v[36:39]
    v_mfma_f32_16x16x32_bf16 v[36:39], v[60:63], v[80:83], v[36:39]
    v_mfma_f32_16x16x32_bf16 v[36:39], v[64:67], v[76:79], v[36:39]
    v_mfma_f32_16x16x32_bf16 v[36:39], v[68:71], v[72:75], v[36:39]
    s_waitcnt lgkmcnt(0)
    v_mfma_f32_16x16x32_bf16 v[24:27], v[104:107], v[136:139], v[24:27]
    ds_read_b64 v[40:41], v22 offset:128
    ds_read_b64 v[42:43], v22 offset:136
    v_mfma_f32_16x16x32_bf16 v[28:31], v[104:107], v[148:151], v[28:31]
    ds_read_b128 v[72:75], v23 offset:3712
    ds_read_b64 v[44:45], v22 offset:640
    v_mfma_f32_16x16x32_bf16 v[32:35], v[104:107], v[152:155], v[32:35]
    ds_read_b64 v[46:47], v22 offset:648
    ds_read_b128 v[76:79], v23 offset:3200
    v_mfma_f32_16x16x32_bf16 v[36:39], v[104:107], v[164:167], v[36:39]
    ds_read_b64 v[48:49], v22 offset:1152
    ds_read_b64 v[50:51], v22 offset:1160
    v_mfma_f32_16x16x32_bf16 v[28:31], v[108:111], v[144:147], v[28:31]
    ds_read_b128 v[80:83], v23 offset:2688
    ds_read_b64 v[52:53], v22 offset:1664
    v_mfma_f32_16x16x32_bf16 v[32:35], v[108:111], v[148:151], v[32:35]
    ds_read_b64 v[54:55], v22 offset:1672
    ds_read_b128 v[84:87], v23 offset:2176
    v_mfma_f32_16x16x32_bf16 v[36:39], v[108:111], v[160:163], v[36:39]
    ds_read_b64 v[56:57], v22 offset:2176
    ds_read_b64 v[58:59], v22 offset:2184
    v_mfma_f32_16x16x32_bf16 v[28:31], v[112:115], v[140:143], v[28:31]
    ds_read_b128 v[88:91], v23 offset:1664
    ds_read_b64 v[60:61], v22 offset:2688
    v_mfma_f32_16x16x32_bf16 v[32:35], v[112:115], v[144:147], v[32:35]
    ds_read_b64 v[62:63], v22 offset:2696
    ds_read_b128 v[92:95], v23 offset:1152
    v_mfma_f32_16x16x32_bf16 v[36:39], v[112:115], v[156:159], v[36:39]
    ds_read_b64 v[64:65], v22 offset:3200
    ds_read_b64 v[66:67], v22 offset:3208
    v_mfma_f32_16x16x32_bf16 v[28:31], v[116:119], v[136:139], v[28:31]
    ds_read_b128 v[96:99], v23 offset:640
    ds_read_b64 v[68:69], v22 offset:3712
    v_mfma_f32_16x16x32_bf16 v[32:35], v[116:119], v[140:143], v[32:35]
    ds_read_b64 v[70:71], v22 offset:3720
    ds_read_b128 v[100:103], v23 offset:128
    v_mfma_f32_16x16x32_bf16 v[36:39], v[116:119], v[152:155], v[36:39]
    v_mfma_f32_16x16x32_bf16 v[32:35], v[120:123], v[136:139], v[32:35]
    v_mfma_f32_16x16x32_bf16 v[36:39], v[120:123], v[148:151], v[36:39]
    v_mfma_f32_16x16x32_bf16 v[36:39], v[124:127], v[144:147], v[36:39]
    v_mfma_f32_16x16x32_bf16 v[36:39], v[128:131], v[140:143], v[36:39]
    v_mfma_f32_16x16x32_bf16 v[36:39], v[132:135], v[136:139], v[36:39]
    s_waitcnt lgkmcnt(0)
    v_mfma_f32_16x16x32_bf16 v[24:27], v[40:43], v[72:75], v[24:27]
    ds_read_b64 v[104:105], v22 offset:192
    ds_read_b64 v[106:107], v22 offset:200
    v_mfma_f32_16x16x32_bf16 v[28:31], v[40:43], v[84:87], v[28:31]
    ds_read_b128 v[136:139], v23 offset:3776
    ds_read_b64 v[108:109], v22 offset:704
    v_mfma_f32_16x16x32_bf16 v[32:35], v[40:43], v[88:91], v[32:35]
    ds_read_b64 v[110:111], v22 offset:712
    ds_read_b128 v[140:143], v23 offset:3264
    v_mfma_f32_16x16x32_bf16 v[36:39], v[40:43], v[100:103], v[36:39]
    ds_read_b64 v[112:113], v22 offset:1216
    ds_read_b64 v[114:115], v22 offset:1224
    v_mfma_f32_16x16x32_bf16 v[28:31], v[44:47], v[80:83], v[28:31]
    ds_read_b128 v[144:147], v23 offset:2752
    ds_read_b64 v[116:117], v22 offset:1728
    v_mfma_f32_16x16x32_bf16 v[32:35], v[44:47], v[84:87], v[32:35]
    ds_read_b64 v[118:119], v22 offset:1736
    ds_read_b128 v[148:151], v23 offset:2240
    v_mfma_f32_16x16x32_bf16 v[36:39], v[44:47], v[96:99], v[36:39]
    ds_read_b64 v[120:121], v22 offset:2240
    ds_read_b64 v[122:123], v22 offset:2248
    v_mfma_f32_16x16x32_bf16 v[28:31], v[48:51], v[76:79], v[28:31]
    ds_read_b128 v[152:155], v23 offset:1728
    ds_read_b64 v[124:125], v22 offset:2752
    v_mfma_f32_16x16x32_bf16 v[32:35], v[48:51], v[80:83], v[32:35]
    ds_read_b64 v[126:127], v22 offset:2760
    ds_read_b128 v[156:159], v23 offset:1216
    v_mfma_f32_16x16x32_bf16 v[36:39], v[48:51], v[92:95], v[36:39]
    ds_read_b64 v[128:129], v22 offset:3264
    ds_read_b64 v[130:131], v22 offset:3272
    v_mfma_f32_16x16x32_bf16 v[28:31], v[52:55], v[72:75], v[28:31]
    ds_read_b128 v[160:163], v23 offset:704
    ds_read_b64 v[132:133], v22 offset:3776
    v_mfma_f32_16x16x32_bf16 v[32:35], v[52:55], v[76:79], v[32:35]
    ds_read_b64 v[134:135], v22 offset:3784
    ds_read_b128 v[164:167], v23 offset:192
    v_mfma_f32_16x16x32_bf16 v[36:39], v[52:55], v[88:91], v[36:39]
    v_mfma_f32_16x16x32_bf16 v[32:35], v[56:59], v[72:75], v[32:35]
    v_mfma_f32_16x16x32_bf16 v[36:39], v[56:59], v[84:87], v[36:39]
    v_mfma_f32_16x16x32_bf16 v[36:39], v[60:63], v[80:83], v[36:39]
    v_mfma_f32_16x16x32_bf16 v[36:39], v[64:67], v[76:79], v[36:39]
    v_mfma_f32_16x16x32_bf16 v[36:39], v[68:71], v[72:75], v[36:39]
    s_waitcnt lgkmcnt(0)
    v_mfma_f32_16x16x32_bf16 v[24:27], v[104:107], v[136:139], v[24:27]
    ds_read_b64 v[40:41], v22 offset:256
    ds_read_b64 v[42:43], v22 offset:264
    v_mfma_f32_16x16x32_bf16 v[28:31], v[104:107], v[148:151], v[28:31]
    ds_read_b128 v[72:75], v23 offset:3840
    ds_read_b64 v[44:45], v22 offset:768
    v_mfma_f32_16x16x32_bf16 v[32:35], v[104:107], v[152:155], v[32:35]
    ds_read_b64 v[46:47], v22 offset:776
    ds_read_b128 v[76:79], v23 offset:3328
    v_mfma_f32_16x16x32_bf16 v[36:39], v[104:107], v[164:167], v[36:39]
    ds_read_b64 v[48:49], v22 offset:1280
    ds_read_b64 v[50:51], v22 offset:1288
    v_mfma_f32_16x16x32_bf16 v[28:31], v[108:111], v[144:147], v[28:31]
    ds_read_b128 v[80:83], v23 offset:2816
    ds_read_b64 v[52:53], v22 offset:1792
    v_mfma_f32_16x16x32_bf16 v[32:35], v[108:111], v[148:151], v[32:35]
    ds_read_b64 v[54:55], v22 offset:1800
    ds_read_b128 v[84:87], v23 offset:2304
    v_mfma_f32_16x16x32_bf16 v[36:39], v[108:111], v[160:163], v[36:39]
    ds_read_b64 v[56:57], v22 offset:2304
    ds_read_b64 v[58:59], v22 offset:2312
    v_mfma_f32_16x16x32_bf16 v[28:31], v[112:115], v[140:143], v[28:31]
    ds_read_b128 v[88:91], v23 offset:1792
    ds_read_b64 v[60:61], v22 offset:2816
    v_mfma_f32_16x16x32_bf16 v[32:35], v[112:115], v[144:147], v[32:35]
    ds_read_b64 v[62:63], v22 offset:2824
    ds_read_b128 v[92:95], v23 offset:1280
    v_mfma_f32_16x16x32_bf16 v[36:39], v[112:115], v[156:159], v[36:39]
    ds_read_b64 v[64:65], v22 offset:3328
    ds_read_b64 v[66:67], v22 offset:3336
    v_mfma_f32_16x16x32_bf16 v[28:31], v[116:119], v[136:139], v[28:31]
    ds_read_b128 v[96:99], v23 offset:768
    ds_read_b64 v[68:69], v22 offset:3840
    v_mfma_f32_16x16x32_bf16 v[32:35], v[116:119], v[140:143], v[32:35]
    ds_read_b64 v[70:71], v22 offset:3848
    ds_read_b128 v[100:103], v23 offset:256
    v_mfma_f32_16x16x32_bf16 v[36:39], v[116:119], v[152:155], v[36:39]
    v_mfma_f32_16x16x32_bf16 v[32:35], v[120:123], v[136:139], v[32:35]
    v_mfma_f32_16x16x32_bf16 v[36:39], v[120:123], v[148:151], v[36:39]
    v_mfma_f32_16x16x32_bf16 v[36:39], v[124:127], v[144:147], v[36:39]
    v_mfma_f32_16x16x32_bf16 v[36:39], v[128:131], v[140:143], v[36:39]
    v_mfma_f32_16x16x32_bf16 v[36:39], v[132:135], v[136:139], v[36:39]
    s_waitcnt lgkmcnt(0)
    v_mfma_f32_16x16x32_bf16 v[24:27], v[40:43], v[72:75], v[24:27]
    ds_read_b64 v[104:105], v22 offset:320
    ds_read_b64 v[106:107], v22 offset:328
    v_mfma_f32_16x16x32_bf16 v[28:31], v[40:43], v[84:87], v[28:31]
    ds_read_b128 v[136:139], v23 offset:3904
    ds_read_b64 v[108:109], v22 offset:832
    v_mfma_f32_16x16x32_bf16 v[32:35], v[40:43], v[88:91], v[32:35]
    ds_read_b64 v[110:111], v22 offset:840
    ds_read_b128 v[140:143], v23 offset:3392
    v_mfma_f32_16x16x32_bf16 v[36:39], v[40:43], v[100:103], v[36:39]
    ds_read_b64 v[112:113], v22 offset:1344
    ds_read_b64 v[114:115], v22 offset:1352
    v_mfma_f32_16x16x32_bf16 v[28:31], v[44:47], v[80:83], v[28:31]
    ds_read_b128 v[144:147], v23 offset:2880
    ds_read_b64 v[116:117], v22 offset:1856
    v_mfma_f32_16x16x32_bf16 v[32:35], v[44:47], v[84:87], v[32:35]
    ds_read_b64 v[118:119], v22 offset:1864
    ds_read_b128 v[148:151], v23 offset:2368
    v_mfma_f32_16x16x32_bf16 v[36:39], v[44:47], v[96:99], v[36:39]
    ds_read_b64 v[120:121], v22 offset:2368
    ds_read_b64 v[122:123], v22 offset:2376
    v_mfma_f32_16x16x32_bf16 v[28:31], v[48:51], v[76:79], v[28:31]
    ds_read_b128 v[152:155], v23 offset:1856
    ds_read_b64 v[124:125], v22 offset:2880
    v_mfma_f32_16x16x32_bf16 v[32:35], v[48:51], v[80:83], v[32:35]
    ds_read_b64 v[126:127], v22 offset:2888
    ds_read_b128 v[156:159], v23 offset:1344
    v_mfma_f32_16x16x32_bf16 v[36:39], v[48:51], v[92:95], v[36:39]
    ds_read_b64 v[128:129], v22 offset:3392
    ds_read_b64 v[130:131], v22 offset:3400
    v_mfma_f32_16x16x32_bf16 v[28:31], v[52:55], v[72:75], v[28:31]
    ds_read_b128 v[160:163], v23 offset:832
    ds_read_b64 v[132:133], v22 offset:3904
    v_mfma_f32_16x16x32_bf16 v[32:35], v[52:55], v[76:79], v[32:35]
    ds_read_b64 v[134:135], v22 offset:3912
    ds_read_b128 v[164:167], v23 offset:320
    v_mfma_f32_16x16x32_bf16 v[36:39], v[52:55], v[88:91], v[36:39]
    v_mfma_f32_16x16x32_bf16 v[32:35], v[56:59], v[72:75], v[32:35]
    v_mfma_f32_16x16x32_bf16 v[36:39], v[56:59], v[84:87], v[36:39]
    v_mfma_f32_16x16x32_bf16 v[36:39], v[60:63], v[80:83], v[36:39]
    v_mfma_f32_16x16x32_bf16 v[36:39], v[64:67], v[76:79], v[36:39]
    v_mfma_f32_16x16x32_bf16 v[36:39], v[68:71], v[72:75], v[36:39]
    s_waitcnt lgkmcnt(0)
    v_mfma_f32_16x16x32_bf16 v[24:27], v[104:107], v[136:139], v[24:27]
    ds_read_b64 v[40:41], v22 offset:384
    ds_read_b64 v[42:43], v22 offset:392
    v_mfma_f32_16x16x32_bf16 v[28:31], v[104:107], v[148:151], v[28:31]
    ds_read_b128 v[72:75], v23 offset:3968
    ds_read_b64 v[44:45], v22 offset:896
    v_mfma_f32_16x16x32_bf16 v[32:35], v[104:107], v[152:155], v[32:35]
    ds_read_b64 v[46:47], v22 offset:904
    ds_read_b128 v[76:79], v23 offset:3456
    v_mfma_f32_16x16x32_bf16 v[36:39], v[104:107], v[164:167], v[36:39]
    ds_read_b64 v[48:49], v22 offset:1408
    ds_read_b64 v[50:51], v22 offset:1416
    v_mfma_f32_16x16x32_bf16 v[28:31], v[108:111], v[144:147], v[28:31]
    ds_read_b128 v[80:83], v23 offset:2944
    ds_read_b64 v[52:53], v22 offset:1920
    v_mfma_f32_16x16x32_bf16 v[32:35], v[108:111], v[148:151], v[32:35]
    ds_read_b64 v[54:55], v22 offset:1928
    ds_read_b128 v[84:87], v23 offset:2432
    v_mfma_f32_16x16x32_bf16 v[36:39], v[108:111], v[160:163], v[36:39]
    ds_read_b64 v[56:57], v22 offset:2432
    ds_read_b64 v[58:59], v22 offset:2440
    v_mfma_f32_16x16x32_bf16 v[28:31], v[112:115], v[140:143], v[28:31]
    ds_read_b128 v[88:91], v23 offset:1920
    ds_read_b64 v[60:61], v22 offset:2944
    v_mfma_f32_16x16x32_bf16 v[32:35], v[112:115], v[144:147], v[32:35]
    ds_read_b64 v[62:63], v22 offset:2952
    ds_read_b128 v[92:95], v23 offset:1408
    v_mfma_f32_16x16x32_bf16 v[36:39], v[112:115], v[156:159], v[36:39]
    ds_read_b64 v[64:65], v22 offset:3456
    ds_read_b64 v[66:67], v22 offset:3464
    v_mfma_f32_16x16x32_bf16 v[28:31], v[116:119], v[136:139], v[28:31]
    ds_read_b128 v[96:99], v23 offset:896
    ds_read_b64 v[68:69], v22 offset:3968
    v_mfma_f32_16x16x32_bf16 v[32:35], v[116:119], v[140:143], v[32:35]
    ds_read_b64 v[70:71], v22 offset:3976
    ds_read_b128 v[100:103], v23 offset:384
    v_mfma_f32_16x16x32_bf16 v[36:39], v[116:119], v[152:155], v[36:39]
    v_mfma_f32_16x16x32_bf16 v[32:35], v[120:123], v[136:139], v[32:35]
    v_mfma_f32_16x16x32_bf16 v[36:39], v[120:123], v[148:151], v[36:39]
    v_mfma_f32_16x16x32_bf16 v[36:39], v[124:127], v[144:147], v[36:39]
    v_mfma_f32_16x16x32_bf16 v[36:39], v[128:131], v[140:143], v[36:39]
    v_mfma_f32_16x16x32_bf16 v[36:39], v[132:135], v[136:139], v[36:39]
    s_waitcnt lgkmcnt(0)
    v_mfma_f32_16x16x32_bf16 v[24:27], v[40:43], v[72:75], v[24:27]
    ds_read_b64 v[104:105], v22 offset:448
    ds_read_b64 v[106:107], v22 offset:456
    v_mfma_f32_16x16x32_bf16 v[28:31], v[40:43], v[84:87], v[28:31]
    ds_read_b128 v[136:139], v23 offset:4032
    ds_read_b64 v[108:109], v22 offset:960
    v_mfma_f32_16x16x32_bf16 v[32:35], v[40:43], v[88:91], v[32:35]
    ds_read_b64 v[110:111], v22 offset:968
    ds_read_b128 v[140:143], v23 offset:3520
    v_mfma_f32_16x16x32_bf16 v[36:39], v[40:43], v[100:103], v[36:39]
    ds_read_b64 v[112:113], v22 offset:1472
    ds_read_b64 v[114:115], v22 offset:1480
    v_mfma_f32_16x16x32_bf16 v[28:31], v[44:47], v[80:83], v[28:31]
    ds_read_b128 v[144:147], v23 offset:3008
    ds_read_b64 v[116:117], v22 offset:1984
    v_mfma_f32_16x16x32_bf16 v[32:35], v[44:47], v[84:87], v[32:35]
    ds_read_b64 v[118:119], v22 offset:1992
    ds_read_b128 v[148:151], v23 offset:2496
    v_mfma_f32_16x16x32_bf16 v[36:39], v[44:47], v[96:99], v[36:39]
    ds_read_b64 v[120:121], v22 offset:2496
    ds_read_b64 v[122:123], v22 offset:2504
    v_mfma_f32_16x16x32_bf16 v[28:31], v[48:51], v[76:79], v[28:31]
    ds_read_b128 v[152:155], v23 offset:1984
    ds_read_b64 v[124:125], v22 offset:3008
    v_mfma_f32_16x16x32_bf16 v[32:35], v[48:51], v[80:83], v[32:35]
    ds_read_b64 v[126:127], v22 offset:3016
    ds_read_b128 v[156:159], v23 offset:1472
    v_mfma_f32_16x16x32_bf16 v[36:39], v[48:51], v[92:95], v[36:39]
    ds_read_b64 v[128:129], v22 offset:3520
    ds_read_b64 v[130:131], v22 offset:3528
    v_mfma_f32_16x16x32_bf16 v[28:31], v[52:55], v[72:75], v[28:31]
    ds_read_b128 v[160:163], v23 offset:960
    ds_read_b64 v[132:133], v22 offset:4032
    v_mfma_f32_16x16x32_bf16 v[32:35], v[52:55], v[76:79], v[32:35]
    ds_read_b64 v[134:135], v22 offset:4040
    ds_read_b128 v[164:167], v23 offset:448
    v_mfma_f32_16x16x32_bf16 v[36:39], v[52:55], v[88:91], v[36:39]
    v_mfma_f32_16x16x32_bf16 v[32:35], v[56:59], v[72:75], v[32:35]
    v_mfma_f32_16x16x32_bf16 v[36:39], v[56:59], v[84:87], v[36:39]
    v_mfma_f32_16x16x32_bf16 v[36:39], v[60:63], v[80:83], v[36:39]
    v_mfma_f32_16x16x32_bf16 v[36:39], v[64:67], v[76:79], v[36:39]
    v_mfma_f32_16x16x32_bf16 v[36:39], v[68:71], v[72:75], v[36:39]
    s_waitcnt lgkmcnt(0)
    v_mfma_f32_16x16x32_bf16 v[24:27], v[104:107], v[136:139], v[24:27]
    v_mfma_f32_16x16x32_bf16 v[28:31], v[104:107], v[148:151], v[28:31]
    v_mfma_f32_16x16x32_bf16 v[32:35], v[104:107], v[152:155], v[32:35]
    v_mfma_f32_16x16x32_bf16 v[36:39], v[104:107], v[164:167], v[36:39]
    v_mfma_f32_16x16x32_bf16 v[28:31], v[108:111], v[144:147], v[28:31]
    v_mfma_f32_16x16x32_bf16 v[32:35], v[108:111], v[148:151], v[32:35]
    v_mfma_f32_16x16x32_bf16 v[36:39], v[108:111], v[160:163], v[36:39]
    v_mfma_f32_16x16x32_bf16 v[28:31], v[112:115], v[140:143], v[28:31]
    v_mfma_f32_16x16x32_bf16 v[32:35], v[112:115], v[144:147], v[32:35]
    v_mfma_f32_16x16x32_bf16 v[36:39], v[112:115], v[156:159], v[36:39]
    v_mfma_f32_16x16x32_bf16 v[28:31], v[116:119], v[136:139], v[28:31]
    v_mfma_f32_16x16x32_bf16 v[32:35], v[116:119], v[140:143], v[32:35]
    v_mfma_f32_16x16x32_bf16 v[36:39], v[116:119], v[152:155], v[36:39]
    v_mfma_f32_16x16x32_bf16 v[32:35], v[120:123], v[136:139], v[32:35]
    v_mfma_f32_16x16x32_bf16 v[36:39], v[120:123], v[148:151], v[36:39]
    v_mfma_f32_16x16x32_bf16 v[36:39], v[124:127], v[144:147], v[36:39]
    v_mfma_f32_16x16x32_bf16 v[36:39], v[128:131], v[140:143], v[36:39]
    v_mfma_f32_16x16x32_bf16 v[36:39], v[132:135], v[136:139], v[36:39]
    ds_read_b64 v[40:41], v19 offset:3584
    ds_read_b64 v[42:43], v19 offset:2048
    ds_read_b64 v[44:45], v19 offset:1536
    ds_read_b64 v[46:47], v19 offset:0
    s_waitcnt lgkmcnt(0)
    s_nop 4
    v_and_b32 v48, 0xffff0000, v41
    v_lshlrev_b32 v49, 16, v41
    v_and_b32 v50, 0xffff0000, v40
    v_lshlrev_b32 v51, 16, v40
    v_fma_f32 v48, s95, v48, v24
    v_fma_f32 v49, s95, v49, v25
    v_fma_f32 v50, s95, v50, v26
    v_fma_f32 v51, s95, v51, v27
    v_cvt_pk_bf16_f32 v52, v48, v49
    v_cvt_pk_bf16_f32 v53, v50, v51
    buffer_store_dwordx2 v[52:53], v8, s[28:31], s59 offen offset:0 sc1
    v_and_b32 v56, 0xffff0000, v43
    v_lshlrev_b32 v57, 16, v43
    v_and_b32 v58, 0xffff0000, v42
    v_lshlrev_b32 v59, 16, v42
    v_fma_f32 v56, s95, v56, v28
    v_fma_f32 v57, s95, v57, v29
    v_fma_f32 v58, s95, v58, v30
    v_fma_f32 v59, s95, v59, v31
    v_cvt_pk_bf16_f32 v60, v56, v57
    v_cvt_pk_bf16_f32 v61, v58, v59
    buffer_store_dwordx2 v[60:61], v8, s[28:31], s59 offen offset:1536 sc1
    v_and_b32 v64, 0xffff0000, v45
    v_lshlrev_b32 v65, 16, v45
    v_and_b32 v66, 0xffff0000, v44
    v_lshlrev_b32 v67, 16, v44
    v_fma_f32 v64, s95, v64, v32
    v_fma_f32 v65, s95, v65, v33
    v_fma_f32 v66, s95, v66, v34
    v_fma_f32 v67, s95, v67, v35
    v_cvt_pk_bf16_f32 v68, v64, v65
    v_cvt_pk_bf16_f32 v69, v66, v67
    buffer_store_dwordx2 v[68:69], v8, s[28:31], s59 offen offset:2048 sc1
    v_and_b32 v72, 0xffff0000, v47
    v_lshlrev_b32 v73, 16, v47
    v_and_b32 v74, 0xffff0000, v46
    v_lshlrev_b32 v75, 16, v46
    v_fma_f32 v72, s95, v72, v36
    v_fma_f32 v73, s95, v73, v37
    v_fma_f32 v74, s95, v74, v38
    v_fma_f32 v75, s95, v75, v39
    v_cvt_pk_bf16_f32 v76, v72, v73
    v_cvt_pk_bf16_f32 v77, v74, v75
    buffer_store_dwordx2 v[76:77], v8, s[28:31], s59 offen offset:3584 sc1
    s_branch k_conv_done
k_conv1:
    ds_read_b64 v[40:41], v22 offset:0
    ds_read_b64 v[42:43], v22 offset:8
    ds_read_b128 v[72:75], v23 offset:3584
    ds_read_b64 v[44:45], v22 offset:512
    ds_read_b64 v[46:47], v22 offset:520
    ds_read_b128 v[76:79], v23 offset:3072
    ds_read_b64 v[48:49], v22 offset:1024
    ds_read_b64 v[50:51], v22 offset:1032
    ds_read_b128 v[80:83], v23 offset:2560
    ds_read_b64 v[52:53], v22 offset:1536
    ds_read_b64 v[54:55], v22 offset:1544
    ds_read_b128 v[84:87], v23 offset:2048
    ds_read_b64 v[56:57], v22 offset:2048
    ds_read_b64 v[58:59], v22 offset:2056
    ds_read_b128 v[88:91], v23 offset:1536
    ds_read_b64 v[60:61], v22 offset:2560
    ds_read_b64 v[62:63], v22 offset:2568
    ds_read_b128 v[92:95], v23 offset:1024
    ds_read_b64 v[64:65], v22 offset:3072
    ds_read_b64 v[66:67], v22 offset:3080
    ds_read_b128 v[96:99], v23 offset:512
    s_waitcnt lgkmcnt(0)
    v_mfma_f32_16x16x32_bf16 v[24:27], v[40:43], v[76:79], 0
    ds_read_b64 v[104:105], v22 offset:64
    ds_read_b64 v[106:107], v22 offset:72
    v_mfma_f32_16x16x32_bf16 v[28:31], v[40:43], v[80:83], 0
    ds_read_b128 v[136:139], v23 offset:3648
    ds_read_b64 v[108:109], v22 offset:576
    v_mfma_f32_16x16x32_bf16 v[32:35], v[40:43], v[92:95], 0
    ds_read_b64 v[110:111], v22 offset:584
    ds_read_b128 v[140:143], v23 offset:3136
    v_mfma_f32_16x16x32_bf16 v[36:39], v[40:43], v[96:99], 0
    ds_read_b64 v[112:113], v22 offset:1088
    ds_read_b64 v[114:115], v22 offset:1096
    v_mfma_f32_16x16x32_bf16 v[24:27], v[44:47], v[72:75], v[24:27]
    ds_read_b128 v[144:147], v23 offset:2624
    ds_read_b64 v[116:117], v22 offset:1600
    v_mfma_f32_16x16x32_bf16 v[28:31], v[44:47], v[76:79], v[28:31]
    ds_read_b64 v[118:119], v22 offset:1608
    ds_read_b128 v[148:151], v23 offset:2112
    v_mfma_f32_16x16x32_bf16 v[32:35], v[44:47], v[88:91], v[32:35]
    ds_read_b64 v[120:121], v22 offset:2112
    ds_read_b64 v[122:123], v22 offset:2120
    v_mfma_f32_16x16x32_bf16 v[36:39], v[44:47], v[92:95], v[36:39]
    ds_read_b128 v[152:155], v23 offset:1600
    ds_read_b64 v[124:125], v22 offset:2624
    v_mfma_f32_16x16x32_bf16 v[28:31], v[48:51], v[72:75], v[28:31]
    ds_read_b64 v[126:127], v22 offset:2632
    ds_read_b128 v[156:159], v23 offset:1088
    v_mfma_f32_16x16x32_bf16 v[32:35], v[48:51], v[84:87], v[32:35]
    ds_read_b64 v[128:129], v22 offset:3136
    ds_read_b64 v[130:131], v22 offset:3144
    v_mfma_f32_16x16x32_bf16 v[36:39], v[48:51], v[88:91], v[36:39]
    ds_read_b128 v[160:163], v23 offset:576
    v_mfma_f32_16x16x32_bf16 v[32:35], v[52:55], v[80:83], v[32:35]
    v_mfma_f32_16x16x32_bf16 v[36:39], v[52:55], v[84:87], v[36:39]
    v_mfma_f32_16x16x32_bf16 v[32:35], v[56:59], v[76:79], v[32:35]
    v_mfma_f32_16x16x32_bf16 v[36:39], v[56:59], v[80:83], v[36:39]
    v_mfma_f32_16x16x32_bf16 v[32:35], v[60:63], v[72:75], v[32:35]
    v_mfma_f32_16x16x32_bf16 v[36:39], v[60:63], v[76:79], v[36:39]
    v_mfma_f32_16x16x32_bf16 v[36:39], v[64:67], v[72:75], v[36:39]
    s_waitcnt lgkmcnt(0)
    v_mfma_f32_16x16x32_bf16 v[24:27], v[104:107], v[140:143], v[24:27]
    ds_read_b64 v[40:41], v22 offset:128
    ds_read_b64 v[42:43], v22 offset:136
    v_mfma_f32_16x16x32_bf16 v[28:31], v[104:107], v[144:147], v[28:31]
    ds_read_b128 v[72:75], v23 offset:3712
    ds_read_b64 v[44:45], v22 offset:640
    v_mfma_f32_16x16x32_bf16 v[32:35], v[104:107], v[156:159], v[32:35]
    ds_read_b64 v[46:47], v22 offset:648
    ds_read_b128 v[76:79], v23 offset:3200
    v_mfma_f32_16x16x32_bf16 v[36:39], v[104:107], v[160:163], v[36:39]
    ds_read_b64 v[48:49], v22 offset:1152
    ds_read_b64 v[50:51], v22 offset:1160
    v_mfma_f32_16x16x32_bf16 v[24:27], v[108:111], v[136:139], v[24:27]
    ds_read_b128 v[80:83], v23 offset:2688
    ds_read_b64 v[52:53], v22 offset:1664
    v_mfma_f32_16x16x32_bf16 v[28:31], v[108:111], v[140:143], v[28:31]
    ds_read_b64 v[54:55], v22 offset:1672
    ds_read_b128 v[84:87], v23 offset:2176
    v_mfma_f32_16x16x32_bf16 v[32:35], v[108:111], v[152:155], v[32:35]
    ds_read_b64 v[56:57], v22 offset:2176
    ds_read_b64 v[58:59], v22 offset:2184
    v_mfma_f32_16x16x32_bf16 v[36:39], v[108:111], v[156:159], v[36:39]
    ds_read_b128 v[88:91], v23 offset:1664
    ds_read_b64 v[60:61], v22 offset:2688
    v_mfma_f32_16x16x32_bf16 v[28:31], v[112:115], v[136:139], v[28:31]
    ds_read_b64 v[62:63], v22 offset:2696
    ds_read_b128 v[92:95], v23 offset:1152
    v_mfma_f32_16x16x32_bf16 v[32:35], v[112:115], v[148:151], v[32:35]
    ds_read_b64 v[64:65], v22 offset:3200
    ds_read_b64 v[66:67], v22 offset:3208
    v_mfma_f32_16x16x32_bf16 v[36:39], v[112:115], v[152:155], v[36:39]
    ds_read_b128 v[96:99], v23 offset:640
    v_mfma_f32_16x16x32_bf16 v[32:35], v[116:119], v[144:147], v[32:35]
    v_mfma_f32_16x16x32_bf16 v[36:39], v[116:119], v[148:151], v[36:39]
    v_mfma_f32_16x16x32_bf16 v[32:35], v[120:123], v[140:143], v[32:35]
    v_mfma_f32_16x16x32_bf16 v[36:39], v[120:123], v[144:147], v[36:39]
    v_mfma_f32_16x16x32_bf16 v[32:35], v[124:127], v[136:139], v[32:35]
    v_mfma_f32_16x16x32_bf16 v[36:39], v[124:127], v[140:143], v[36:39]
    v_mfma_f32_16x16x32_bf16 v[36:39], v[128:131], v[136:139], v[36:39]
    s_waitcnt lgkmcnt(0)
    v_mfma_f32_16x16x32_bf16 v[24:27], v[40:43], v[76:79], v[24:27]
    ds_read_b64 v[104:105], v22 offset:192
    ds_read_b64 v[106:107], v22 offset:200
    v_mfma_f32_16x16x32_bf16 v[28:31], v[40:43], v[80:83], v[28:31]
    ds_read_b128 v[136:139], v23 offset:3776
    ds_read_b64 v[108:109], v22 offset:704
    v_mfma_f32_16x16x32_bf16 v[32:35], v[40:43], v[92:95], v[32:35]
    ds_read_b64 v[110:111], v22 offset:712
    ds_read_b128 v[140:143], v23 offset:3264
    v_mfma_f32_16x16x32_bf16 v[36:39], v[40:43], v[96:99], v[36:39]
    ds_read_b64 v[112:113], v22 offset:1216
    ds_read_b64 v[114:115], v22 offset:1224
    v_mfma_f32_16x16x32_bf16 v[24:27], v[44:47], v[72:75], v[24:27]
    ds_read_b128 v[144:147], v23 offset:2752
    ds_read_b64 v[116:117], v22 offset:1728
    v_mfma_f32_16x16x32_bf16 v[28:31], v[44:47], v[76:79], v[28:31]
    ds_read_b64 v[118:119], v22 offset:1736
    ds_read_b128 v[148:151], v23 offset:2240
    v_mfma_f32_16x16x32_bf16 v[32:35], v[44:47], v[88:91], v[32:35]
    ds_read_b64 v[120:121], v22 offset:2240
    ds_read_b64 v[122:123], v22 offset:2248
    v_mfma_f32_16x16x32_bf16 v[36:39], v[44:47], v[92:95], v[36:39]
    ds_read_b128 v[152:155], v23 offset:1728
    ds_read_b64 v[124:125], v22 offset:2752
    v_mfma_f32_16x16x32_bf16 v[28:31], v[48:51], v[72:75], v[28:31]
    ds_read_b64 v[126:127], v22 offset:2760
    ds_read_b128 v[156:159], v23 offset:1216
    v_mfma_f32_16x16x32_bf16 v[32:35], v[48:51], v[84:87], v[32:35]
    ds_read_b64 v[128:129], v22 offset:3264
    ds_read_b64 v[130:131], v22 offset:3272
    v_mfma_f32_16x16x32_bf16 v[36:39], v[48:51], v[88:91], v[36:39]
    ds_read_b128 v[160:163], v23 offset:704
    v_mfma_f32_16x16x32_bf16 v[32:35], v[52:55], v[80:83], v[32:35]
    v_mfma_f32_16x16x32_bf16 v[36:39], v[52:55], v[84:87], v[36:39]
    v_mfma_f32_16x16x32_bf16 v[32:35], v[56:59], v[76:79], v[32:35]
    v_mfma_f32_16x16x32_bf16 v[36:39], v[56:59], v[80:83], v[36:39]
    v_mfma_f32_16x16x32_bf16 v[32:35], v[60:63], v[72:75], v[32:35]
    v_mfma_f32_16x16x32_bf16 v[36:39], v[60:63], v[76:79], v[36:39]
    v_mfma_f32_16x16x32_bf16 v[36:39], v[64:67], v[72:75], v[36:39]
    s_waitcnt lgkmcnt(0)
    v_mfma_f32_16x16x32_bf16 v[24:27], v[104:107], v[140:143], v[24:27]
    ds_read_b64 v[40:41], v22 offset:256
    ds_read_b64 v[42:43], v22 offset:264
    v_mfma_f32_16x16x32_bf16 v[28:31], v[104:107], v[144:147], v[28:31]
    ds_read_b128 v[72:75], v23 offset:3840
    ds_read_b64 v[44:45], v22 offset:768
    v_mfma_f32_16x16x32_bf16 v[32:35], v[104:107], v[156:159], v[32:35]
    ds_read_b64 v[46:47], v22 offset:776
    ds_read_b128 v[76:79], v23 offset:3328
    v_mfma_f32_16x16x32_bf16 v[36:39], v[104:107], v[160:163], v[36:39]
    ds_read_b64 v[48:49], v22 offset:1280
    ds_read_b64 v[50:51], v22 offset:1288
    v_mfma_f32_16x16x32_bf16 v[24:27], v[108:111], v[136:139], v[24:27]
    ds_read_b128 v[80:83], v23 offset:2816
    ds_read_b64 v[52:53], v22 offset:1792
    v_mfma_f32_16x16x32_bf16 v[28:31], v[108:111], v[140:143], v[28:31]
    ds_read_b64 v[54:55], v22 offset:1800
    ds_read_b128 v[84:87], v23 offset:2304
    v_mfma_f32_16x16x32_bf16 v[32:35], v[108:111], v[152:155], v[32:35]
    ds_read_b64 v[56:57], v22 offset:2304
    ds_read_b64 v[58:59], v22 offset:2312
    v_mfma_f32_16x16x32_bf16 v[36:39], v[108:111], v[156:159], v[36:39]
    ds_read_b128 v[88:91], v23 offset:1792
    ds_read_b64 v[60:61], v22 offset:2816
    v_mfma_f32_16x16x32_bf16 v[28:31], v[112:115], v[136:139], v[28:31]
    ds_read_b64 v[62:63], v22 offset:2824
    ds_read_b128 v[92:95], v23 offset:1280
    v_mfma_f32_16x16x32_bf16 v[32:35], v[112:115], v[148:151], v[32:35]
    ds_read_b64 v[64:65], v22 offset:3328
    ds_read_b64 v[66:67], v22 offset:3336
    v_mfma_f32_16x16x32_bf16 v[36:39], v[112:115], v[152:155], v[36:39]
    ds_read_b128 v[96:99], v23 offset:768
    v_mfma_f32_16x16x32_bf16 v[32:35], v[116:119], v[144:147], v[32:35]
    v_mfma_f32_16x16x32_bf16 v[36:39], v[116:119], v[148:151], v[36:39]
    v_mfma_f32_16x16x32_bf16 v[32:35], v[120:123], v[140:143], v[32:35]
    v_mfma_f32_16x16x32_bf16 v[36:39], v[120:123], v[144:147], v[36:39]
    v_mfma_f32_16x16x32_bf16 v[32:35], v[124:127], v[136:139], v[32:35]
    v_mfma_f32_16x16x32_bf16 v[36:39], v[124:127], v[140:143], v[36:39]
    v_mfma_f32_16x16x32_bf16 v[36:39], v[128:131], v[136:139], v[36:39]
    s_waitcnt lgkmcnt(0)
    v_mfma_f32_16x16x32_bf16 v[24:27], v[40:43], v[76:79], v[24:27]
    ds_read_b64 v[104:105], v22 offset:320
    ds_read_b64 v[106:107], v22 offset:328
    v_mfma_f32_16x16x32_bf16 v[28:31], v[40:43], v[80:83], v[28:31]
    ds_read_b128 v[136:139], v23 offset:3904
    ds_read_b64 v[108:109], v22 offset:832
    v_mfma_f32_16x16x32_bf16 v[32:35], v[40:43], v[92:95], v[32:35]
    ds_read_b64 v[110:111], v22 offset:840
    ds_read_b128 v[140:143], v23 offset:3392
    v_mfma_f32_16x16x32_bf16 v[36:39], v[40:43], v[96:99], v[36:39]
    ds_read_b64 v[112:113], v22 offset:1344
    ds_read_b64 v[114:115], v22 offset:1352
    v_mfma_f32_16x16x32_bf16 v[24:27], v[44:47], v[72:75], v[24:27]
    ds_read_b128 v[144:147], v23 offset:2880
    ds_read_b64 v[116:117], v22 offset:1856
    v_mfma_f32_16x16x32_bf16 v[28:31], v[44:47], v[76:79], v[28:31]
    ds_read_b64 v[118:119], v22 offset:1864
    ds_read_b128 v[148:151], v23 offset:2368
    v_mfma_f32_16x16x32_bf16 v[32:35], v[44:47], v[88:91], v[32:35]
    ds_read_b64 v[120:121], v22 offset:2368
    ds_read_b64 v[122:123], v22 offset:2376
    v_mfma_f32_16x16x32_bf16 v[36:39], v[44:47], v[92:95], v[36:39]
    ds_read_b128 v[152:155], v23 offset:1856
    ds_read_b64 v[124:125], v22 offset:2880
    v_mfma_f32_16x16x32_bf16 v[28:31], v[48:51], v[72:75], v[28:31]
    ds_read_b64 v[126:127], v22 offset:2888
    ds_read_b128 v[156:159], v23 offset:1344
    v_mfma_f32_16x16x32_bf16 v[32:35], v[48:51], v[84:87], v[32:35]
    ds_read_b64 v[128:129], v22 offset:3392
    ds_read_b64 v[130:131], v22 offset:3400
    v_mfma_f32_16x16x32_bf16 v[36:39], v[48:51], v[88:91], v[36:39]
    ds_read_b128 v[160:163], v23 offset:832
    v_mfma_f32_16x16x32_bf16 v[32:35], v[52:55], v[80:83], v[32:35]
    v_mfma_f32_16x16x32_bf16 v[36:39], v[52:55], v[84:87], v[36:39]
    v_mfma_f32_16x16x32_bf16 v[32:35], v[56:59], v[76:79], v[32:35]
    v_mfma_f32_16x16x32_bf16 v[36:39], v[56:59], v[80:83], v[36:39]
    v_mfma_f32_16x16x32_bf16 v[32:35], v[60:63], v[72:75], v[32:35]
    v_mfma_f32_16x16x32_bf16 v[36:39], v[60:63], v[76:79], v[36:39]
    v_mfma_f32_16x16x32_bf16 v[36:39], v[64:67], v[72:75], v[36:39]
    s_waitcnt lgkmcnt(0)
    v_mfma_f32_16x16x32_bf16 v[24:27], v[104:107], v[140:143], v[24:27]
    ds_read_b64 v[40:41], v22 offset:384
    ds_read_b64 v[42:43], v22 offset:392
    v_mfma_f32_16x16x32_bf16 v[28:31], v[104:107], v[144:147], v[28:31]
    ds_read_b128 v[72:75], v23 offset:3968
    ds_read_b64 v[44:45], v22 offset:896
    v_mfma_f32_16x16x32_bf16 v[32:35], v[104:107], v[156:159], v[32:35]
    ds_read_b64 v[46:47], v22 offset:904
    ds_read_b128 v[76:79], v23 offset:3456
    v_mfma_f32_16x16x32_bf16 v[36:39], v[104:107], v[160:163], v[36:39]
    ds_read_b64 v[48:49], v22 offset:1408
    ds_read_b64 v[50:51], v22 offset:1416
    v_mfma_f32_16x16x32_bf16 v[24:27], v[108:111], v[136:139], v[24:27]
    ds_read_b128 v[80:83], v23 offset:2944
    ds_read_b64 v[52:53], v22 offset:1920
    v_mfma_f32_16x16x32_bf16 v[28:31], v[108:111], v[140:143], v[28:31]
    ds_read_b64 v[54:55], v22 offset:1928
    ds_read_b128 v[84:87], v23 offset:2432
    v_mfma_f32_16x16x32_bf16 v[32:35], v[108:111], v[152:155], v[32:35]
    ds_read_b64 v[56:57], v22 offset:2432
    ds_read_b64 v[58:59], v22 offset:2440
    v_mfma_f32_16x16x32_bf16 v[36:39], v[108:111], v[156:159], v[36:39]
    ds_read_b128 v[88:91], v23 offset:1920
    ds_read_b64 v[60:61], v22 offset:2944
    v_mfma_f32_16x16x32_bf16 v[28:31], v[112:115], v[136:139], v[28:31]
    ds_read_b64 v[62:63], v22 offset:2952
    ds_read_b128 v[92:95], v23 offset:1408
    v_mfma_f32_16x16x32_bf16 v[32:35], v[112:115], v[148:151], v[32:35]
    ds_read_b64 v[64:65], v22 offset:3456
    ds_read_b64 v[66:67], v22 offset:3464
    v_mfma_f32_16x16x32_bf16 v[36:39], v[112:115], v[152:155], v[36:39]
    ds_read_b128 v[96:99], v23 offset:896
    v_mfma_f32_16x16x32_bf16 v[32:35], v[116:119], v[144:147], v[32:35]
    v_mfma_f32_16x16x32_bf16 v[36:39], v[116:119], v[148:151], v[36:39]
    v_mfma_f32_16x16x32_bf16 v[32:35], v[120:123], v[140:143], v[32:35]
    v_mfma_f32_16x16x32_bf16 v[36:39], v[120:123], v[144:147], v[36:39]
    v_mfma_f32_16x16x32_bf16 v[32:35], v[124:127], v[136:139], v[32:35]
    v_mfma_f32_16x16x32_bf16 v[36:39], v[124:127], v[140:143], v[36:39]
    v_mfma_f32_16x16x32_bf16 v[36:39], v[128:131], v[136:139], v[36:39]
    s_waitcnt lgkmcnt(0)
    v_mfma_f32_16x16x32_bf16 v[24:27], v[40:43], v[76:79], v[24:27]
    ds_read_b64 v[104:105], v22 offset:448
    ds_read_b64 v[106:107], v22 offset:456
    v_mfma_f32_16x16x32_bf16 v[28:31], v[40:43], v[80:83], v[28:31]
    ds_read_b128 v[136:139], v23 offset:4032
    ds_read_b64 v[108:109], v22 offset:960
    v_mfma_f32_16x16x32_bf16 v[32:35], v[40:43], v[92:95], v[32:35]
    ds_read_b64 v[110:111], v22 offset:968
    ds_read_b128 v[140:143], v23 offset:3520
    v_mfma_f32_16x16x32_bf16 v[36:39], v[40:43], v[96:99], v[36:39]
    ds_read_b64 v[112:113], v22 offset:1472
    ds_read_b64 v[114:115], v22 offset:1480
    v_mfma_f32_16x16x32_bf16 v[24:27], v[44:47], v[72:75], v[24:27]
    ds_read_b128 v[144:147], v23 offset:3008
    ds_read_b64 v[116:117], v22 offset:1984
    v_mfma_f32_16x16x32_bf16 v[28:31], v[44:47], v[76:79], v[28:31]
    ds_read_b64 v[118:119], v22 offset:1992
    ds_read_b128 v[148:151], v23 offset:2496
    v_mfma_f32_16x16x32_bf16 v[32:35], v[44:47], v[88:91], v[32:35]
    ds_read_b64 v[120:121], v22 offset:2496
    ds_read_b64 v[122:123], v22 offset:2504
    v_mfma_f32_16x16x32_bf16 v[36:39], v[44:47], v[92:95], v[36:39]
    ds_read_b128 v[152:155], v23 offset:1984
    ds_read_b64 v[124:125], v22 offset:3008
    v_mfma_f32_16x16x32_bf16 v[28:31], v[48:51], v[72:75], v[28:31]
    ds_read_b64 v[126:127], v22 offset:3016
    ds_read_b128 v[156:159], v23 offset:1472
    v_mfma_f32_16x16x32_bf16 v[32:35], v[48:51], v[84:87], v[32:35]
    ds_read_b64 v[128:129], v22 offset:3520
    ds_read_b64 v[130:131], v22 offset:3528
    v_mfma_f32_16x16x32_bf16 v[36:39], v[48:51], v[88:91], v[36:39]
    ds_read_b128 v[160:163], v23 offset:960
    v_mfma_f32_16x16x32_bf16 v[32:35], v[52:55], v[80:83], v[32:35]
    v_mfma_f32_16x16x32_bf16 v[36:39], v[52:55], v[84:87], v[36:39]
    v_mfma_f32_16x16x32_bf16 v[32:35], v[56:59], v[76:79], v[32:35]
    v_mfma_f32_16x16x32_bf16 v[36:39], v[56:59], v[80:83], v[36:39]
    v_mfma_f32_16x16x32_bf16 v[32:35], v[60:63], v[72:75], v[32:35]
    v_mfma_f32_16x16x32_bf16 v[36:39], v[60:63], v[76:79], v[36:39]
    v_mfma_f32_16x16x32_bf16 v[36:39], v[64:67], v[72:75], v[36:39]
    s_waitcnt lgkmcnt(0)
    v_mfma_f32_16x16x32_bf16 v[24:27], v[104:107], v[140:143], v[24:27]
    v_mfma_f32_16x16x32_bf16 v[28:31], v[104:107], v[144:147], v[28:31]
    v_mfma_f32_16x16x32_bf16 v[32:35], v[104:107], v[156:159], v[32:35]
    v_mfma_f32_16x16x32_bf16 v[36:39], v[104:107], v[160:163], v[36:39]
    v_mfma_f32_16x16x32_bf16 v[24:27], v[108:111], v[136:139], v[24:27]
    v_mfma_f32_16x16x32_bf16 v[28:31], v[108:111], v[140:143], v[28:31]
    v_mfma_f32_16x16x32_bf16 v[32:35], v[108:111], v[152:155], v[32:35]
    v_mfma_f32_16x16x32_bf16 v[36:39], v[108:111], v[156:159], v[36:39]
    v_mfma_f32_16x16x32_bf16 v[28:31], v[112:115], v[136:139], v[28:31]
    v_mfma_f32_16x16x32_bf16 v[32:35], v[112:115], v[148:151], v[32:35]
    v_mfma_f32_16x16x32_bf16 v[36:39], v[112:115], v[152:155], v[36:39]
    v_mfma_f32_16x16x32_bf16 v[32:35], v[116:119], v[144:147], v[32:35]
    v_mfma_f32_16x16x32_bf16 v[36:39], v[116:119], v[148:151], v[36:39]
    v_mfma_f32_16x16x32_bf16 v[32:35], v[120:123], v[140:143], v[32:35]
    v_mfma_f32_16x16x32_bf16 v[36:39], v[120:123], v[144:147], v[36:39]
    v_mfma_f32_16x16x32_bf16 v[32:35], v[124:127], v[136:139], v[32:35]
    v_mfma_f32_16x16x32_bf16 v[36:39], v[124:127], v[140:143], v[36:39]
    v_mfma_f32_16x16x32_bf16 v[36:39], v[128:131], v[136:139], v[36:39]
    ds_read_b64 v[40:41], v19 offset:3072
    ds_read_b64 v[42:43], v19 offset:2560
    ds_read_b64 v[44:45], v19 offset:1024
    ds_read_b64 v[46:47], v19 offset:512
    s_waitcnt lgkmcnt(0)
    s_nop 4
    v_and_b32 v48, 0xffff0000, v41
    v_lshlrev_b32 v49, 16, v41
    v_and_b32 v50, 0xffff0000, v40
    v_lshlrev_b32 v51, 16, v40
    v_fma_f32 v48, s95, v48, v24
    v_fma_f32 v49, s95, v49, v25
    v_fma_f32 v50, s95, v50, v26
    v_fma_f32 v51, s95, v51, v27
    v_cvt_pk_bf16_f32 v52, v48, v49
    v_cvt_pk_bf16_f32 v53, v50, v51
    buffer_store_dwordx2 v[52:53], v8, s[28:31], s59 offen offset:512 sc1
    v_and_b32 v56, 0xffff0000, v43
    v_lshlrev_b32 v57, 16, v43
    v_and_b32 v58, 0xffff0000, v42
    v_lshlrev_b32 v59, 16, v42
    v_fma_f32 v56, s95, v56, v28
    v_fma_f32 v57, s95, v57, v29
    v_fma_f32 v58, s95, v58, v30
    v_fma_f32 v59, s95, v59, v31
    v_cvt_pk_bf16_f32 v60, v56, v57
    v_cvt_pk_bf16_f32 v61, v58, v59
    buffer_store_dwordx2 v[60:61], v8, s[28:31], s59 offen offset:1024 sc1
    v_and_b32 v64, 0xffff0000, v45
    v_lshlrev_b32 v65, 16, v45
    v_and_b32 v66, 0xffff0000, v44
    v_lshlrev_b32 v67, 16, v44
    v_fma_f32 v64, s95, v64, v32
    v_fma_f32 v65, s95, v65, v33
    v_fma_f32 v66, s95, v66, v34
    v_fma_f32 v67, s95, v67, v35
    v_cvt_pk_bf16_f32 v68, v64, v65
    v_cvt_pk_bf16_f32 v69, v66, v67
    buffer_store_dwordx2 v[68:69], v8, s[28:31], s59 offen offset:2560 sc1
    v_and_b32 v72, 0xffff0000, v47
    v_lshlrev_b32 v73, 16, v47
    v_and_b32 v74, 0xffff0000, v46
    v_lshlrev_b32 v75, 16, v46
    v_fma_f32 v72, s95, v72, v36
    v_fma_f32 v73, s95, v73, v37
    v_fma_f32 v74, s95, v74, v38
    v_fma_f32 v75, s95, v75, v39
    v_cvt_pk_bf16_f32 v76, v72, v73
    v_cvt_pk_bf16_f32 v77, v74, v75
    buffer_store_dwordx2 v[76:77], v8, s[28:31], s59 offen offset:3072 sc1
k_conv_done:
    s_lshr_b32 s33, s2, 5
    s_lshl_b32 s33, s33, 12
    s_and_b32 s34, s2, 31
    s_lshl_b32 s34, s34, 2
    s_add_u32 s33, s33, s34
    s_add_u32 s33, s33, 9240704
    v_lshrrev_b32 v5, 3, v1
    v_mul_u32_u24 v5, 28672, v5
    v_and_b32 v6, 7, v1
    v_lshl_add_u32 v5, v6, 9, v5
    s_waitcnt vmcnt(0)
    v_mov_b32 v2, 1
    v_mov_b32 v3, 153608
    s_mov_b64 exec, 1
    ds_add_rtn_u32 v4, v3, v2
    s_mov_b64 exec, -1
    s_waitcnt lgkmcnt(0)
    v_readfirstlane_b32 s92, v4
    s_nop 3
    s_cmp_lg_u32 s92, 3
    s_cbranch_scc1 nopub_35
    s_mov_b32 exec_lo, 0xffffffff
    s_mov_b32 exec_hi, 0
    buffer_store_dword v2, v5, s[28:31], s33 offen sc1
    s_mov_b64 exec, -1
nopub_35:
    s_cmp_lg_u32 s32, 8
    s_cbranch_scc1 k_nost_36
    s_lshl_b32 s33, s2, 9
    s_and_b32 s34, s52, 3
    s_lshl_b32 s34, s34, 4
    s_add_u32 s33, s33, s34
    s_add_u32 s33, s33, 9240576
    v_min_u32 v3, 3, v1
    v_lshlrev_b32 v3, 2, v3
poll_37:
    buffer_load_dword v2, v3, s[28:31], s33 offen sc1
    s_waitcnt vmcnt(0)
    v_cmp_ne_u32 vcc, 1, v2
    s_nop 3
    s_cmp_eq_u64 vcc, 0
    s_cbranch_scc1 polled_38
    s_sleep 8
    s_branch poll_37
polled_38:
    v_lshlrev_b32 v7, 3, v1
    s_lshl_b32 s35, s52, 9
    s_add_u32 s35, s35, 9175040
    buffer_load_dwordx2 v[24:25], v7, s[28:31], s35 offen sc1
    v_add_u32 v7, 153088, v7
    s_waitcnt vmcnt(0)
    ds_write_b64 v7, v[24:25]
k_nost_36:
    v_lshrrev_b32 v6, 3, v1
    v_and_b32 v7, 7, v1
    v_lshlrev_b32 v5, 4, v7
    v_lshl_add_u32 v5, v6, 12, v5
    s_lshl_b32 s34, s53, 18
    s_lshl_b32 s35, s52, 7
    s_add_u32 s34, s34, s35
    s_lshl_b32 s35, s54, 16
    s_add_u32 s34, s34, s35
    s_add_u32 s34, s34, 9437184
    s_add_u32 s35, s34, 32768
    s_lshl_b32 s33, s54, 1
    v_xor_b32 v8, s33, v7
    v_lshlrev_b32 v8, 4, v8
    v_lshl_add_u32 v8, v7, 10, v8
    v_lshl_add_u32 v8, v6, 1, v8
    v_add_u32 v8, 144896, v8
    v_xor_b32 v9, 16, v8
    s_lshl_b32 s33, s2, 9
    s_lshl_b32 s93, s54, 5
    s_add_u32 s33, s33, s93
    s_add_u32 s33, s33, 9240704
    v_min_u32 v3, 7, v1
    v_lshlrev_b32 v3, 2, v3
poll_39:
    buffer_load_dword v2, v3, s[28:31], s33 offen sc1
    s_waitcnt vmcnt(0)
    v_cmp_ne_u32 vcc, 1, v2
    s_nop 3
    s_cmp_eq_u64 vcc, 0
    s_cbranch_scc1 polled_40
    s_sleep 8
    s_branch poll_39
polled_40:
    buffer_load_dwordx4 v[24:27], v5, s[28:31], s34 offen sc1
    buffer_load_dwordx4 v[28:31], v5, s[28:31], s35 offen sc1
    s_waitcnt vmcnt(1)
    ds_write_b16 v8, v24 offset:0
    ds_write_b16_d16_hi v8, v24 offset:128
    ds_write_b16 v8, v25 offset:256
    ds_write_b16_d16_hi v8, v25 offset:384
    ds_write_b16 v8, v26 offset:512
    ds_write_b16_d16_hi v8, v26 offset:640
    ds_write_b16 v8, v27 offset:768
    ds_write_b16_d16_hi v8, v27 offset:896
    s_waitcnt vmcnt(0)
    ds_write_b16 v9, v28 offset:0
    ds_write_b16_d16_hi v9, v28 offset:128
    ds_write_b16 v9, v29 offset:256
    ds_write_b16_d16_hi v9, v29 offset:384
    ds_write_b16 v9, v30 offset:512
    ds_write_b16_d16_hi v9, v30 offset:640
    ds_write_b16 v9, v31 offset:768
    ds_write_b16_d16_hi v9, v31 offset:896
    s_waitcnt lgkmcnt(0)
    s_barrier
    s_endpgm
k_final:
    v_lshrrev_b32 v2, 3, v0
    v_and_b32 v3, 7, v0
    v_lshlrev_b32 v7, 3, v2
    v_add_u32 v148, 153088, v7
    v_lshrrev_b32 v4, 2, v3
    v_lshrrev_b32 v5, 5, v2
    v_lshl_add_u32 v5, v5, 1, v4
    v_and_b32 v6, 3, v3
    v_lshlrev_b32 v6, 1, v6
    v_xor_b32 v6, v6, v4
    v_and_b32 v7, 7, v2
    v_xor_b32 v6, v6, v7
    v_lshlrev_b32 v6, 4, v6
    v_and_b32 v7, 31, v2
    v_lshl_add_u32 v6, v7, 7, v6
    v_cmp_eq_u32 vcc, 3, v5
    v_lshl_add_u32 v7, v5, 12, v6
    v_add_u32 v6, 98304, v6
    v_mov_b32 v8, 12288
    v_cndmask_b32 v132, v7, v6, vcc
    v_mov_b32 v9, 0x1000
    v_cndmask_b32 v8, v8, v9, vcc
    v_add_u32 v133, v132, v8
    v_add_u32 v134, v133, v8
    v_add_u32 v135, v134, v8
    v_add_u32 v136, v135, v8
    v_add_u32 v137, v136, v8
    v_add_u32 v138, v137, v8
    v_add_u32 v139, v138, v8
    v_xor_b32 v140, 16, v132
    v_xor_b32 v141, 16, v133
    v_xor_b32 v142, 16, v134
    v_xor_b32 v143, 16, v135
    v_xor_b32 v144, 16, v136
    v_xor_b32 v145, 16, v137
    v_xor_b32 v146, 16, v138
    v_xor_b32 v147, 16, v139
    v_lshrrev_b32 v6, 3, v2
    v_xor_b32 v6, v6, v3
    v_lshlrev_b32 v6, 4, v6
    v_lshl_add_u32 v6, v2, 7, v6
    v_add_u32 v149, 144896, v6
    s_mov_b32 s40, s22
    s_and_b32 s41, s23, 0xffff
    s_mov_b32 s42, 1835008
    s_mov_b32 s43, 0x00020000
    s_waitcnt vmcnt(0)
    v_lshlrev_b32 v152, 16, v128
    v_and_b32 v153, 0xffff0000, v128
    v_lshlrev_b32 v154, 16, v129
    v_and_b32 v155, 0xffff0000, v129
    v_lshlrev_b32 v156, 16, v130
    v_and_b32 v157, 0xffff0000, v130
    v_lshlrev_b32 v158, 16, v131
    v_and_b32 v159, 0xffff0000, v131
    s_waitcnt lgkmcnt(0)
    s_barrier
    ds_read_b64 v[18:19], v148
    ds_read_b128 v[24:27], v132
    ds_read_b128 v[28:31], v140
    ds_read_b128 v[32:35], v133
    ds_read_b128 v[36:39], v141
    ds_read_b128 v[40:43], v134
    ds_read_b128 v[44:47], v142
    ds_read_b128 v[48:51], v135
    ds_read_b128 v[52:55], v143
    ds_read_b128 v[96:99], v136
    ds_read_b128 v[100:103], v144
    ds_read_b128 v[104:107], v137
    ds_read_b128 v[108:111], v145
    s_waitcnt lgkmcnt(8)
    ds_read_b128 v[112:115], v138
    ds_read_b128 v[116:119], v146
    ds_read_b128 v[120:123], v139
    ds_read_b128 v[124:127], v147
    ds_read_b128 v[56:59], v149
    v_rcp_f32 v21, v19
    v_sub_f32 v72, v152, v18
    v_sub_f32 v73, v153, v18
    v_sub_f32 v74, v154, v18
    v_sub_f32 v75, v155, v18
    v_sub_f32 v76, v156, v18
    v_sub_f32 v77, v157, v18
    v_sub_f32 v78, v158, v18
    v_sub_f32 v79, v159, v18
    v_mul_f32 v22, v21, v21
    v_mul_f32 v72, v72, v21
    v_mul_f32 v73, v73, v21
    v_mul_f32 v74, v74, v21
    v_mul_f32 v75, v75, v21
    v_mul_f32 v76, v76, v21
    v_mul_f32 v77, v77, v21
    v_mul_f32 v78, v78, v21
    v_mul_f32 v79, v79, v21
    s_waitcnt lgkmcnt(0)
    v_pk_add_f32 v[24:25], v[24:25], v[32:33]
    v_pk_add_f32 v[26:27], v[26:27], v[34:35]
    v_pk_add_f32 v[28:29], v[28:29], v[36:37]
    v_pk_add_f32 v[30:31], v[30:31], v[38:39]
    v_pk_add_f32 v[40:41], v[40:41], v[48:49]
    v_pk_add_f32 v[42:43], v[42:43], v[50:51]
    v_pk_add_f32 v[44:45], v[44:45], v[52:53]
    v_pk_add_f32 v[46:47], v[46:47], v[54:55]
    v_pk_add_f32 v[96:97], v[96:97], v[104:105]
    v_pk_add_f32 v[98:99], v[98:99], v[106:107]
    v_pk_add_f32 v[100:101], v[100:101], v[108:109]
    v_pk_add_f32 v[102:103], v[102:103], v[110:111]
    v_pk_add_f32 v[112:113], v[112:113], v[120:121]
    v_pk_add_f32 v[114:115], v[114:115], v[122:123]
    v_pk_add_f32 v[116:117], v[116:117], v[124:125]
    v_pk_add_f32 v[118:119], v[118:119], v[126:127]
    v_pk_add_f32 v[24:25], v[24:25], v[40:41]
    v_pk_add_f32 v[26:27], v[26:27], v[42:43]
    v_pk_add_f32 v[28:29], v[28:29], v[44:45]
    v_pk_add_f32 v[30:31], v[30:31], v[46:47]
    v_pk_add_f32 v[96:97], v[96:97], v[112:113]
    v_pk_add_f32 v[98:99], v[98:99], v[114:115]
    v_pk_add_f32 v[100:101], v[100:101], v[116:117]
    v_pk_add_f32 v[102:103], v[102:103], v[118:119]
    v_pk_add_f32 v[24:25], v[24:25], v[96:97]
    v_pk_add_f32 v[26:27], v[26:27], v[98:99]
    v_pk_add_f32 v[28:29], v[28:29], v[100:101]
    v_pk_add_f32 v[30:31], v[30:31], v[102:103]
    v_mul_f32 v24, v24, v22
    v_mul_f32 v25, v25, v22
    v_mul_f32 v26, v26, v22
    v_mul_f32 v27, v27, v22
    v_mul_f32 v28, v28, v22
    v_mul_f32 v29, v29, v22
    v_mul_f32 v30, v30, v22
    v_mul_f32 v31, v31, v22
    v_mul_f32 v32, 0xbfb8aa3b, v24
    v_mul_f32 v33, 0xbfb8aa3b, v25
    v_mul_f32 v34, 0xbfb8aa3b, v26
    v_mul_f32 v35, 0xbfb8aa3b, v27
    v_mul_f32 v36, 0xbfb8aa3b, v28
    v_mul_f32 v37, 0xbfb8aa3b, v29
    v_mul_f32 v38, 0xbfb8aa3b, v30
    v_mul_f32 v39, 0xbfb8aa3b, v31
    v_exp_f32 v32, v32
    v_exp_f32 v33, v33
    v_exp_f32 v34, v34
    v_exp_f32 v35, v35
    v_exp_f32 v36, v36
    v_exp_f32 v37, v37
    v_exp_f32 v38, v38
    v_exp_f32 v39, v39
    v_lshlrev_b32 v80, 16, v56
    v_and_b32 v81, 0xffff0000, v56
    v_lshlrev_b32 v82, 16, v57
    v_and_b32 v83, 0xffff0000, v57
    v_lshlrev_b32 v84, 16, v58
    v_and_b32 v85, 0xffff0000, v58
    v_lshlrev_b32 v86, 16, v59
    v_and_b32 v87, 0xffff0000, v59
    v_add_f32 v32, 1.0, v32
    v_add_f32 v33, 1.0, v33
    v_add_f32 v34, 1.0, v34
    v_add_f32 v35, 1.0, v35
    v_add_f32 v36, 1.0, v36
    v_add_f32 v37, 1.0, v37
    v_add_f32 v38, 1.0, v38
    v_add_f32 v39, 1.0, v39
    v_rcp_f32 v32, v32
    v_rcp_f32 v33, v33
    v_rcp_f32 v34, v34
    v_rcp_f32 v35, v35
    v_rcp_f32 v36, v36
    v_rcp_f32 v37, v37
    v_rcp_f32 v38, v38
    v_rcp_f32 v39, v39
    v_mul_f32 v72, v72, v80
    v_mul_f32 v73, v73, v81
    v_mul_f32 v74, v74, v82
    v_mul_f32 v75, v75, v83
    v_mul_f32 v76, v76, v84
    v_mul_f32 v77, v77, v85
    v_mul_f32 v78, v78, v86
    v_mul_f32 v79, v79, v87
    v_mul_f32 v24, v24, v32
    v_mul_f32 v25, v25, v33
    v_mul_f32 v26, v26, v34
    v_mul_f32 v27, v27, v35
    v_mul_f32 v28, v28, v36
    v_mul_f32 v29, v29, v37
    v_mul_f32 v30, v30, v38
    v_mul_f32 v31, v31, v39
    v_fma_f32 v24, v72, v24, v152
    v_fma_f32 v25, v73, v25, v153
    v_fma_f32 v26, v74, v26, v154
    v_fma_f32 v27, v75, v27, v155
    v_fma_f32 v28, v76, v28, v156
    v_fma_f32 v29, v77, v29, v157
    v_fma_f32 v30, v78, v30, v158
    v_fma_f32 v31, v79, v31, v159
    v_cvt_pk_bf16_f32 v88, v24, v25
    v_cvt_pk_bf16_f32 v89, v26, v27
    v_cvt_pk_bf16_f32 v90, v28, v29
    v_cvt_pk_bf16_f32 v91, v30, v31
    buffer_store_dwordx4 v[88:91], v14, s[40:43], 0 offen sc1
    s_endpgm
k_prep:
    s_sub_u32 s54, s2, 224
    s_waitcnt lgkmcnt(0)
    s_mov_b32 s28, s26
    s_and_b32 s29, s27, 0xffff
    s_mov_b32 s30, 16777216
    s_mov_b32 s31, 0x00020000
    s_cmp_ge_u32 s32, 8
    s_cbranch_scc1 k_end
    s_cmp_eq_u32 s32, 7
    s_cbranch_scc1 k_prep_flags
    s_mov_b32 s36, s6
    s_and_b32 s37, s7, 0xffff
    s_mov_b32 s38, 1835008
    s_mov_b32 s39, 0x00020000
    s_mov_b32 s40, s8
    s_and_b32 s41, s9, 0xffff
    s_mov_b32 s42, 1835008
    s_mov_b32 s43, 0x00020000
    s_mov_b32 s44, s10
    s_and_b32 s45, s11, 0xffff
    s_mov_b32 s46, 3584
    s_mov_b32 s47, 0x00020000
    s_movk_i32 s33, 1171
    v_mul_lo_u32 v2, v0, s33
    v_lshrrev_b32 v2, 16, v2
    v_mul_u32_u24 v3, 56, v2
    v_sub_u32 v3, v0, v3
    s_lshl_b32 s33, s54, 6
    v_lshl_add_u32 v4, v2, 3, s33
    s_movk_i32 s34, 896
    v_mul_lo_u32 v4, v4, s34
    v_lshl_add_u32 v11, v3, 4, v4
    v_subrev_u32 v10, 2688, v11
    v_add_u32 v12, 3584, v11
    v_lshlrev_b32 v13, 6, v3
    buffer_load_dwordx4 v[92:95], v13, s[44:47], 0 offen offset:0
    buffer_load_dwordx4 v[96:99], v13, s[44:47], 0 offen offset:16
    buffer_load_dwordx4 v[100:103], v13, s[44:47], 0 offen offset:32
    buffer_load_dwordx4 v[104:107], v13, s[44:47], 0 offen offset:48
    s_waitcnt vmcnt(0)
    buffer_load_dwordx4 v[16:19], v10, s[36:39], 0 offen offset:0
    buffer_load_dwordx4 v[20:23], v10, s[36:39], 0 offen offset:896
    buffer_load_dwordx4 v[24:27], v10, s[36:39], 0 offen offset:1792
    buffer_load_dwordx4 v[28:31], v11, s[36:39], 0 offen offset:0
    buffer_load_dwordx4 v[32:35], v11, s[36:39], 0 offen offset:896
    buffer_load_dwordx4 v[36:39], v11, s[36:39], 0 offen offset:1792
    buffer_load_dwordx4 v[40:43], v11, s[36:39], 0 offen offset:2688
    buffer_load_dwordx4 v[44:47], v12, s[36:39], 0 offen offset:0
    buffer_load_dwordx4 v[48:51], v12, s[36:39], 0 offen offset:896
    buffer_load_dwordx4 v[52:55], v12, s[36:39], 0 offen offset:1792
    buffer_load_dwordx4 v[56:59], v12, s[36:39], 0 offen offset:2688
    buffer_load_dwordx4 v[60:63], v11, s[40:43], 0 offen offset:0
    buffer_load_dwordx4 v[64:67], v11, s[40:43], 0 offen offset:896
    buffer_load_dwordx4 v[68:71], v11, s[40:43], 0 offen offset:1792
    buffer_load_dwordx4 v[72:75], v11, s[40:43], 0 offen offset:2688
    buffer_load_dwordx4 v[76:79], v12, s[40:43], 0 offen offset:0
    buffer_load_dwordx4 v[80:83], v12, s[40:43], 0 offen offset:896
    buffer_load_dwordx4 v[84:87], v12, s[40:43], 0 offen offset:1792
    buffer_load_dwordx4 v[88:91], v12, s[40:43], 0 offen offset:2688
    v_sub_u32 v5, 7, v2
    v_and_b32 v6, 7, v3
    v_xor_b32 v5, v5, v6
    v_lshlrev_b32 v5, 4, v5
    v_lshl_add_u32 v14, v3, 10, v5
    s_waitcnt vmcnt(0)
    v_lshlrev_b32 v108, 16, v92
    v_and_b32 v110, 0xffff0000, v92
    v_lshlrev_b32 v112, 16, v93
    v_and_b32 v114, 0xffff0000, v93
    v_lshlrev_b32 v109, 16, v94
    v_and_b32 v111, 0xffff0000, v94
    v_lshlrev_b32 v113, 16, v95
    v_and_b32 v115, 0xffff0000, v95
    v_lshlrev_b32 v116, 16, v16
    v_and_b32 v117, 0xffff0000, v16
    v_lshlrev_b32 v118, 16, v20
    v_and_b32 v119, 0xffff0000, v20
    v_lshlrev_b32 v120, 16, v24
    v_and_b32 v121, 0xffff0000, v24
    v_lshlrev_b32 v122, 16, v28
    v_and_b32 v123, 0xffff0000, v28
    v_lshlrev_b32 v124, 16, v32
    v_and_b32 v125, 0xffff0000, v32
    v_lshlrev_b32 v126, 16, v36
    v_and_b32 v127, 0xffff0000, v36
    v_lshlrev_b32 v128, 16, v40
    v_and_b32 v129, 0xffff0000, v40
    v_lshlrev_b32 v130, 16, v44
    v_and_b32 v131, 0xffff0000, v44
    v_lshlrev_b32 v132, 16, v48
    v_and_b32 v133, 0xffff0000, v48
    v_lshlrev_b32 v134, 16, v52
    v_and_b32 v135, 0xffff0000, v52
    v_lshlrev_b32 v136, 16, v56
    v_and_b32 v137, 0xffff0000, v56
    v_pk_mul_f32 v[138:139], v[116:117], v[114:115]
    v_pk_mul_f32 v[140:141], v[118:119], v[114:115]
    v_pk_mul_f32 v[142:143], v[120:121], v[114:115]
    v_pk_mul_f32 v[144:145], v[122:123], v[114:115]
    v_pk_mul_f32 v[146:147], v[124:125], v[114:115]
    v_pk_mul_f32 v[148:149], v[126:127], v[114:115]
    v_pk_mul_f32 v[150:151], v[128:129], v[114:115]
    v_pk_mul_f32 v[152:153], v[130:131], v[114:115]
    v_pk_fma_f32 v[138:139], v[118:119], v[112:113], v[138:139]
    v_pk_fma_f32 v[140:141], v[120:121], v[112:113], v[140:141]
    v_pk_fma_f32 v[142:143], v[122:123], v[112:113], v[142:143]
    v_pk_fma_f32 v[144:145], v[124:125], v[112:113], v[144:145]
    v_pk_fma_f32 v[146:147], v[126:127], v[112:113], v[146:147]
    v_pk_fma_f32 v[148:149], v[128:129], v[112:113], v[148:149]
    v_pk_fma_f32 v[150:151], v[130:131], v[112:113], v[150:151]
    v_pk_fma_f32 v[152:153], v[132:133], v[112:113], v[152:153]
    v_pk_fma_f32 v[138:139], v[120:121], v[110:111], v[138:139]
    v_pk_fma_f32 v[140:141], v[122:123], v[110:111], v[140:141]
    v_pk_fma_f32 v[142:143], v[124:125], v[110:111], v[142:143]
    v_pk_fma_f32 v[144:145], v[126:127], v[110:111], v[144:145]
    v_pk_fma_f32 v[146:147], v[128:129], v[110:111], v[146:147]
    v_pk_fma_f32 v[148:149], v[130:131], v[110:111], v[148:149]
    v_pk_fma_f32 v[150:151], v[132:133], v[110:111], v[150:151]
    v_pk_fma_f32 v[152:153], v[134:135], v[110:111], v[152:153]
    v_pk_fma_f32 v[138:139], v[122:123], v[108:109], v[138:139]
    v_pk_fma_f32 v[140:141], v[124:125], v[108:109], v[140:141]
    v_pk_fma_f32 v[142:143], v[126:127], v[108:109], v[142:143]
    v_pk_fma_f32 v[144:145], v[128:129], v[108:109], v[144:145]
    v_pk_fma_f32 v[146:147], v[130:131], v[108:109], v[146:147]
    v_pk_fma_f32 v[148:149], v[132:133], v[108:109], v[148:149]
    v_pk_fma_f32 v[150:151], v[134:135], v[108:109], v[150:151]
    v_pk_fma_f32 v[152:153], v[136:137], v[108:109], v[152:153]
    v_lshlrev_b32 v116, 16, v60
    v_and_b32 v117, 0xffff0000, v60
    v_lshlrev_b32 v118, 16, v64
    v_and_b32 v119, 0xffff0000, v64
    v_lshlrev_b32 v120, 16, v68
    v_and_b32 v121, 0xffff0000, v68
    v_lshlrev_b32 v122, 16, v72
    v_and_b32 v123, 0xffff0000, v72
    v_lshlrev_b32 v124, 16, v76
    v_and_b32 v125, 0xffff0000, v76
    v_lshlrev_b32 v126, 16, v80
    v_and_b32 v127, 0xffff0000, v80
    v_lshlrev_b32 v128, 16, v84
    v_and_b32 v129, 0xffff0000, v84
    v_lshlrev_b32 v130, 16, v88
    v_and_b32 v131, 0xffff0000, v88
    v_pk_mul_f32 v[138:139], v[138:139], v[116:117]
    v_pk_mul_f32 v[140:141], v[140:141], v[118:119]
    v_pk_mul_f32 v[142:143], v[142:143], v[120:121]
    v_pk_mul_f32 v[144:145], v[144:145], v[122:123]
    v_pk_mul_f32 v[146:147], v[146:147], v[124:125]
    v_pk_mul_f32 v[148:149], v[148:149], v[126:127]
    v_pk_mul_f32 v[150:151], v[150:151], v[128:129]
    v_pk_mul_f32 v[152:153], v[152:153], v[130:131]
    v_cvt_pk_bf16_f32 v154, v152, v150
    v_cvt_pk_bf16_f32 v155, v148, v146
    v_cvt_pk_bf16_f32 v156, v144, v142
    v_cvt_pk_bf16_f32 v157, v140, v138
    v_cvt_pk_bf16_f32 v158, v153, v151
    v_cvt_pk_bf16_f32 v159, v149, v147
    v_cvt_pk_bf16_f32 v160, v145, v143
    v_cvt_pk_bf16_f32 v161, v141, v139
    ds_write_b128 v14, v[154:157] offset:0
    ds_write_b128 v14, v[158:161] offset:128
    v_lshlrev_b32 v108, 16, v96
    v_and_b32 v110, 0xffff0000, v96
    v_lshlrev_b32 v112, 16, v97
    v_and_b32 v114, 0xffff0000, v97
    v_lshlrev_b32 v109, 16, v98
    v_and_b32 v111, 0xffff0000, v98
    v_lshlrev_b32 v113, 16, v99
    v_and_b32 v115, 0xffff0000, v99
    v_lshlrev_b32 v116, 16, v17
    v_and_b32 v117, 0xffff0000, v17
    v_lshlrev_b32 v118, 16, v21
    v_and_b32 v119, 0xffff0000, v21
    v_lshlrev_b32 v120, 16, v25
    v_and_b32 v121, 0xffff0000, v25
    v_lshlrev_b32 v122, 16, v29
    v_and_b32 v123, 0xffff0000, v29
    v_lshlrev_b32 v124, 16, v33
    v_and_b32 v125, 0xffff0000, v33
    v_lshlrev_b32 v126, 16, v37
    v_and_b32 v127, 0xffff0000, v37
    v_lshlrev_b32 v128, 16, v41
    v_and_b32 v129, 0xffff0000, v41
    v_lshlrev_b32 v130, 16, v45
    v_and_b32 v131, 0xffff0000, v45
    v_lshlrev_b32 v132, 16, v49
    v_and_b32 v133, 0xffff0000, v49
    v_lshlrev_b32 v134, 16, v53
    v_and_b32 v135, 0xffff0000, v53
    v_lshlrev_b32 v136, 16, v57
    v_and_b32 v137, 0xffff0000, v57
    v_pk_mul_f32 v[138:139], v[116:117], v[114:115]
    v_pk_mul_f32 v[140:141], v[118:119], v[114:115]
    v_pk_mul_f32 v[142:143], v[120:121], v[114:115]
    v_pk_mul_f32 v[144:145], v[122:123], v[114:115]
    v_pk_mul_f32 v[146:147], v[124:125], v[114:115]
    v_pk_mul_f32 v[148:149], v[126:127], v[114:115]
    v_pk_mul_f32 v[150:151], v[128:129], v[114:115]
    v_pk_mul_f32 v[152:153], v[130:131], v[114:115]
    v_pk_fma_f32 v[138:139], v[118:119], v[112:113], v[138:139]
    v_pk_fma_f32 v[140:141], v[120:121], v[112:113], v[140:141]
    v_pk_fma_f32 v[142:143], v[122:123], v[112:113], v[142:143]
    v_pk_fma_f32 v[144:145], v[124:125], v[112:113], v[144:145]
    v_pk_fma_f32 v[146:147], v[126:127], v[112:113], v[146:147]
    v_pk_fma_f32 v[148:149], v[128:129], v[112:113], v[148:149]
    v_pk_fma_f32 v[150:151], v[130:131], v[112:113], v[150:151]
    v_pk_fma_f32 v[152:153], v[132:133], v[112:113], v[152:153]
    v_pk_fma_f32 v[138:139], v[120:121], v[110:111], v[138:139]
    v_pk_fma_f32 v[140:141], v[122:123], v[110:111], v[140:141]
    v_pk_fma_f32 v[142:143], v[124:125], v[110:111], v[142:143]
    v_pk_fma_f32 v[144:145], v[126:127], v[110:111], v[144:145]
    v_pk_fma_f32 v[146:147], v[128:129], v[110:111], v[146:147]
    v_pk_fma_f32 v[148:149], v[130:131], v[110:111], v[148:149]
    v_pk_fma_f32 v[150:151], v[132:133], v[110:111], v[150:151]
    v_pk_fma_f32 v[152:153], v[134:135], v[110:111], v[152:153]
    v_pk_fma_f32 v[138:139], v[122:123], v[108:109], v[138:139]
    v_pk_fma_f32 v[140:141], v[124:125], v[108:109], v[140:141]
    v_pk_fma_f32 v[142:143], v[126:127], v[108:109], v[142:143]
    v_pk_fma_f32 v[144:145], v[128:129], v[108:109], v[144:145]
    v_pk_fma_f32 v[146:147], v[130:131], v[108:109], v[146:147]
    v_pk_fma_f32 v[148:149], v[132:133], v[108:109], v[148:149]
    v_pk_fma_f32 v[150:151], v[134:135], v[108:109], v[150:151]
    v_pk_fma_f32 v[152:153], v[136:137], v[108:109], v[152:153]
    v_lshlrev_b32 v116, 16, v61
    v_and_b32 v117, 0xffff0000, v61
    v_lshlrev_b32 v118, 16, v65
    v_and_b32 v119, 0xffff0000, v65
    v_lshlrev_b32 v120, 16, v69
    v_and_b32 v121, 0xffff0000, v69
    v_lshlrev_b32 v122, 16, v73
    v_and_b32 v123, 0xffff0000, v73
    v_lshlrev_b32 v124, 16, v77
    v_and_b32 v125, 0xffff0000, v77
    v_lshlrev_b32 v126, 16, v81
    v_and_b32 v127, 0xffff0000, v81
    v_lshlrev_b32 v128, 16, v85
    v_and_b32 v129, 0xffff0000, v85
    v_lshlrev_b32 v130, 16, v89
    v_and_b32 v131, 0xffff0000, v89
    v_pk_mul_f32 v[138:139], v[138:139], v[116:117]
    v_pk_mul_f32 v[140:141], v[140:141], v[118:119]
    v_pk_mul_f32 v[142:143], v[142:143], v[120:121]
    v_pk_mul_f32 v[144:145], v[144:145], v[122:123]
    v_pk_mul_f32 v[146:147], v[146:147], v[124:125]
    v_pk_mul_f32 v[148:149], v[148:149], v[126:127]
    v_pk_mul_f32 v[150:151], v[150:151], v[128:129]
    v_pk_mul_f32 v[152:153], v[152:153], v[130:131]
    v_cvt_pk_bf16_f32 v154, v152, v150
    v_cvt_pk_bf16_f32 v155, v148, v146
    v_cvt_pk_bf16_f32 v156, v144, v142
    v_cvt_pk_bf16_f32 v157, v140, v138
    v_cvt_pk_bf16_f32 v158, v153, v151
    v_cvt_pk_bf16_f32 v159, v149, v147
    v_cvt_pk_bf16_f32 v160, v145, v143
    v_cvt_pk_bf16_f32 v161, v141, v139
    ds_write_b128 v14, v[154:157] offset:256
    ds_write_b128 v14, v[158:161] offset:384
    v_lshlrev_b32 v108, 16, v100
    v_and_b32 v110, 0xffff0000, v100
    v_lshlrev_b32 v112, 16, v101
    v_and_b32 v114, 0xffff0000, v101
    v_lshlrev_b32 v109, 16, v102
    v_and_b32 v111, 0xffff0000, v102
    v_lshlrev_b32 v113, 16, v103
    v_and_b32 v115, 0xffff0000, v103
    v_lshlrev_b32 v116, 16, v18
    v_and_b32 v117, 0xffff0000, v18
    v_lshlrev_b32 v118, 16, v22
    v_and_b32 v119, 0xffff0000, v22
    v_lshlrev_b32 v120, 16, v26
    v_and_b32 v121, 0xffff0000, v26
    v_lshlrev_b32 v122, 16, v30
    v_and_b32 v123, 0xffff0000, v30
    v_lshlrev_b32 v124, 16, v34
    v_and_b32 v125, 0xffff0000, v34
    v_lshlrev_b32 v126, 16, v38
    v_and_b32 v127, 0xffff0000, v38
    v_lshlrev_b32 v128, 16, v42
    v_and_b32 v129, 0xffff0000, v42
    v_lshlrev_b32 v130, 16, v46
    v_and_b32 v131, 0xffff0000, v46
    v_lshlrev_b32 v132, 16, v50
    v_and_b32 v133, 0xffff0000, v50
    v_lshlrev_b32 v134, 16, v54
    v_and_b32 v135, 0xffff0000, v54
    v_lshlrev_b32 v136, 16, v58
    v_and_b32 v137, 0xffff0000, v58
    v_pk_mul_f32 v[138:139], v[116:117], v[114:115]
    v_pk_mul_f32 v[140:141], v[118:119], v[114:115]
    v_pk_mul_f32 v[142:143], v[120:121], v[114:115]
    v_pk_mul_f32 v[144:145], v[122:123], v[114:115]
    v_pk_mul_f32 v[146:147], v[124:125], v[114:115]
    v_pk_mul_f32 v[148:149], v[126:127], v[114:115]
    v_pk_mul_f32 v[150:151], v[128:129], v[114:115]
    v_pk_mul_f32 v[152:153], v[130:131], v[114:115]
    v_pk_fma_f32 v[138:139], v[118:119], v[112:113], v[138:139]
    v_pk_fma_f32 v[140:141], v[120:121], v[112:113], v[140:141]
    v_pk_fma_f32 v[142:143], v[122:123], v[112:113], v[142:143]
    v_pk_fma_f32 v[144:145], v[124:125], v[112:113], v[144:145]
    v_pk_fma_f32 v[146:147], v[126:127], v[112:113], v[146:147]
    v_pk_fma_f32 v[148:149], v[128:129], v[112:113], v[148:149]
    v_pk_fma_f32 v[150:151], v[130:131], v[112:113], v[150:151]
    v_pk_fma_f32 v[152:153], v[132:133], v[112:113], v[152:153]
    v_pk_fma_f32 v[138:139], v[120:121], v[110:111], v[138:139]
    v_pk_fma_f32 v[140:141], v[122:123], v[110:111], v[140:141]
    v_pk_fma_f32 v[142:143], v[124:125], v[110:111], v[142:143]
    v_pk_fma_f32 v[144:145], v[126:127], v[110:111], v[144:145]
    v_pk_fma_f32 v[146:147], v[128:129], v[110:111], v[146:147]
    v_pk_fma_f32 v[148:149], v[130:131], v[110:111], v[148:149]
    v_pk_fma_f32 v[150:151], v[132:133], v[110:111], v[150:151]
    v_pk_fma_f32 v[152:153], v[134:135], v[110:111], v[152:153]
    v_pk_fma_f32 v[138:139], v[122:123], v[108:109], v[138:139]
    v_pk_fma_f32 v[140:141], v[124:125], v[108:109], v[140:141]
    v_pk_fma_f32 v[142:143], v[126:127], v[108:109], v[142:143]
    v_pk_fma_f32 v[144:145], v[128:129], v[108:109], v[144:145]
    v_pk_fma_f32 v[146:147], v[130:131], v[108:109], v[146:147]
    v_pk_fma_f32 v[148:149], v[132:133], v[108:109], v[148:149]
    v_pk_fma_f32 v[150:151], v[134:135], v[108:109], v[150:151]
    v_pk_fma_f32 v[152:153], v[136:137], v[108:109], v[152:153]
    v_lshlrev_b32 v116, 16, v62
    v_and_b32 v117, 0xffff0000, v62
    v_lshlrev_b32 v118, 16, v66
    v_and_b32 v119, 0xffff0000, v66
    v_lshlrev_b32 v120, 16, v70
    v_and_b32 v121, 0xffff0000, v70
    v_lshlrev_b32 v122, 16, v74
    v_and_b32 v123, 0xffff0000, v74
    v_lshlrev_b32 v124, 16, v78
    v_and_b32 v125, 0xffff0000, v78
    v_lshlrev_b32 v126, 16, v82
    v_and_b32 v127, 0xffff0000, v82
    v_lshlrev_b32 v128, 16, v86
    v_and_b32 v129, 0xffff0000, v86
    v_lshlrev_b32 v130, 16, v90
    v_and_b32 v131, 0xffff0000, v90
    v_pk_mul_f32 v[138:139], v[138:139], v[116:117]
    v_pk_mul_f32 v[140:141], v[140:141], v[118:119]
    v_pk_mul_f32 v[142:143], v[142:143], v[120:121]
    v_pk_mul_f32 v[144:145], v[144:145], v[122:123]
    v_pk_mul_f32 v[146:147], v[146:147], v[124:125]
    v_pk_mul_f32 v[148:149], v[148:149], v[126:127]
    v_pk_mul_f32 v[150:151], v[150:151], v[128:129]
    v_pk_mul_f32 v[152:153], v[152:153], v[130:131]
    v_cvt_pk_bf16_f32 v154, v152, v150
    v_cvt_pk_bf16_f32 v155, v148, v146
    v_cvt_pk_bf16_f32 v156, v144, v142
    v_cvt_pk_bf16_f32 v157, v140, v138
    v_cvt_pk_bf16_f32 v158, v153, v151
    v_cvt_pk_bf16_f32 v159, v149, v147
    v_cvt_pk_bf16_f32 v160, v145, v143
    v_cvt_pk_bf16_f32 v161, v141, v139
    ds_write_b128 v14, v[154:157] offset:512
    ds_write_b128 v14, v[158:161] offset:640
    v_lshlrev_b32 v108, 16, v104
    v_and_b32 v110, 0xffff0000, v104
    v_lshlrev_b32 v112, 16, v105
    v_and_b32 v114, 0xffff0000, v105
    v_lshlrev_b32 v109, 16, v106
    v_and_b32 v111, 0xffff0000, v106
    v_lshlrev_b32 v113, 16, v107
    v_and_b32 v115, 0xffff0000, v107
    v_lshlrev_b32 v116, 16, v19
    v_and_b32 v117, 0xffff0000, v19
    v_lshlrev_b32 v118, 16, v23
    v_and_b32 v119, 0xffff0000, v23
    v_lshlrev_b32 v120, 16, v27
    v_and_b32 v121, 0xffff0000, v27
    v_lshlrev_b32 v122, 16, v31
    v_and_b32 v123, 0xffff0000, v31
    v_lshlrev_b32 v124, 16, v35
    v_and_b32 v125, 0xffff0000, v35
    v_lshlrev_b32 v126, 16, v39
    v_and_b32 v127, 0xffff0000, v39
    v_lshlrev_b32 v128, 16, v43
    v_and_b32 v129, 0xffff0000, v43
    v_lshlrev_b32 v130, 16, v47
    v_and_b32 v131, 0xffff0000, v47
    v_lshlrev_b32 v132, 16, v51
    v_and_b32 v133, 0xffff0000, v51
    v_lshlrev_b32 v134, 16, v55
    v_and_b32 v135, 0xffff0000, v55
    v_lshlrev_b32 v136, 16, v59
    v_and_b32 v137, 0xffff0000, v59
    v_pk_mul_f32 v[138:139], v[116:117], v[114:115]
    v_pk_mul_f32 v[140:141], v[118:119], v[114:115]
    v_pk_mul_f32 v[142:143], v[120:121], v[114:115]
    v_pk_mul_f32 v[144:145], v[122:123], v[114:115]
    v_pk_mul_f32 v[146:147], v[124:125], v[114:115]
    v_pk_mul_f32 v[148:149], v[126:127], v[114:115]
    v_pk_mul_f32 v[150:151], v[128:129], v[114:115]
    v_pk_mul_f32 v[152:153], v[130:131], v[114:115]
    v_pk_fma_f32 v[138:139], v[118:119], v[112:113], v[138:139]
    v_pk_fma_f32 v[140:141], v[120:121], v[112:113], v[140:141]
    v_pk_fma_f32 v[142:143], v[122:123], v[112:113], v[142:143]
    v_pk_fma_f32 v[144:145], v[124:125], v[112:113], v[144:145]
    v_pk_fma_f32 v[146:147], v[126:127], v[112:113], v[146:147]
    v_pk_fma_f32 v[148:149], v[128:129], v[112:113], v[148:149]
    v_pk_fma_f32 v[150:151], v[130:131], v[112:113], v[150:151]
    v_pk_fma_f32 v[152:153], v[132:133], v[112:113], v[152:153]
    v_pk_fma_f32 v[138:139], v[120:121], v[110:111], v[138:139]
    v_pk_fma_f32 v[140:141], v[122:123], v[110:111], v[140:141]
    v_pk_fma_f32 v[142:143], v[124:125], v[110:111], v[142:143]
    v_pk_fma_f32 v[144:145], v[126:127], v[110:111], v[144:145]
    v_pk_fma_f32 v[146:147], v[128:129], v[110:111], v[146:147]
    v_pk_fma_f32 v[148:149], v[130:131], v[110:111], v[148:149]
    v_pk_fma_f32 v[150:151], v[132:133], v[110:111], v[150:151]
    v_pk_fma_f32 v[152:153], v[134:135], v[110:111], v[152:153]
    v_pk_fma_f32 v[138:139], v[122:123], v[108:109], v[138:139]
    v_pk_fma_f32 v[140:141], v[124:125], v[108:109], v[140:141]
    v_pk_fma_f32 v[142:143], v[126:127], v[108:109], v[142:143]
    v_pk_fma_f32 v[144:145], v[128:129], v[108:109], v[144:145]
    v_pk_fma_f32 v[146:147], v[130:131], v[108:109], v[146:147]
    v_pk_fma_f32 v[148:149], v[132:133], v[108:109], v[148:149]
    v_pk_fma_f32 v[150:151], v[134:135], v[108:109], v[150:151]
    v_pk_fma_f32 v[152:153], v[136:137], v[108:109], v[152:153]
    v_lshlrev_b32 v116, 16, v63
    v_and_b32 v117, 0xffff0000, v63
    v_lshlrev_b32 v118, 16, v67
    v_and_b32 v119, 0xffff0000, v67
    v_lshlrev_b32 v120, 16, v71
    v_and_b32 v121, 0xffff0000, v71
    v_lshlrev_b32 v122, 16, v75
    v_and_b32 v123, 0xffff0000, v75
    v_lshlrev_b32 v124, 16, v79
    v_and_b32 v125, 0xffff0000, v79
    v_lshlrev_b32 v126, 16, v83
    v_and_b32 v127, 0xffff0000, v83
    v_lshlrev_b32 v128, 16, v87
    v_and_b32 v129, 0xffff0000, v87
    v_lshlrev_b32 v130, 16, v91
    v_and_b32 v131, 0xffff0000, v91
    v_pk_mul_f32 v[138:139], v[138:139], v[116:117]
    v_pk_mul_f32 v[140:141], v[140:141], v[118:119]
    v_pk_mul_f32 v[142:143], v[142:143], v[120:121]
    v_pk_mul_f32 v[144:145], v[144:145], v[122:123]
    v_pk_mul_f32 v[146:147], v[146:147], v[124:125]
    v_pk_mul_f32 v[148:149], v[148:149], v[126:127]
    v_pk_mul_f32 v[150:151], v[150:151], v[128:129]
    v_pk_mul_f32 v[152:153], v[152:153], v[130:131]
    v_cvt_pk_bf16_f32 v154, v152, v150
    v_cvt_pk_bf16_f32 v155, v148, v146
    v_cvt_pk_bf16_f32 v156, v144, v142
    v_cvt_pk_bf16_f32 v157, v140, v138
    v_cvt_pk_bf16_f32 v158, v153, v151
    v_cvt_pk_bf16_f32 v159, v149, v147
    v_cvt_pk_bf16_f32 v160, v145, v143
    v_cvt_pk_bf16_f32 v161, v141, v139
    ds_write_b128 v14, v[154:157] offset:768
    ds_write_b128 v14, v[158:161] offset:896
    s_branch k_prep_bar
k_prep_flags:
    v_mov_b32 v4, 0
    v_mov_b32 v5, 0
    v_mov_b32 v6, 0
    v_mov_b32 v7, 0
    v_lshlrev_b32 v2, 4, v1
    s_mul_i32 s33, s54, 3584
    s_add_u32 s33, s33, 9240576
    buffer_store_dwordx4 v[4:7], v2, s[28:31], s33 offen offset:0 sc1
    buffer_store_dwordx4 v[4:7], v2, s[28:31], s33 offen offset:1024 sc1
    buffer_store_dwordx4 v[4:7], v2, s[28:31], s33 offen offset:2048 sc1
    s_mov_b32 exec_hi, 0
    buffer_store_dwordx4 v[4:7], v2, s[28:31], s33 offen offset:3072 sc1
    s_mov_b64 exec, 1
    v_mov_b32 v3, 1
    s_waitcnt vmcnt(0) lgkmcnt(0)
    global_atomic_add v4, v3, s[24:25] sc1
    s_mov_b64 exec, -1
k_prep_bar:
    s_waitcnt lgkmcnt(0)
    s_barrier
    v_lshrrev_b32 v2, 3, v0
    v_and_b32 v3, 7, v0
    v_xor_b32 v4, s32, v3
    v_lshlrev_b32 v4, 4, v4
    v_lshl_add_u32 v4, v2, 7, v4
    v_lshlrev_b32 v5, 4, v3
    v_lshl_add_u32 v5, v2, 12, v5
    ds_read_b128 v[32:35], v4 offset:0
    ds_read_b128 v[36:39], v4 offset:8192
    ds_read_b128 v[40:43], v4 offset:16384
    ds_read_b128 v[44:47], v4 offset:24576
    ds_read_b128 v[48:51], v4 offset:32768
    ds_read_b128 v[52:55], v4 offset:40960
    ds_read_b128 v[56:59], v4 offset:49152
    s_lshl_b32 s33, s54, 7
    s_sub_u32 s33, 7344000, s33
    s_waitcnt lgkmcnt(6)
    buffer_store_dwordx4 v[32:35], v5, s[28:31], s33 offen sc1
    s_add_u32 s33, s33, 262144
    s_waitcnt lgkmcnt(5)
    buffer_store_dwordx4 v[36:39], v5, s[28:31], s33 offen sc1
    s_add_u32 s33, s33, 262144
    s_waitcnt lgkmcnt(4)
    buffer_store_dwordx4 v[40:43], v5, s[28:31], s33 offen sc1
    s_add_u32 s33, s33, 262144
    s_waitcnt lgkmcnt(3)
    buffer_store_dwordx4 v[44:47], v5, s[28:31], s33 offen sc1
    s_add_u32 s33, s33, 262144
    s_waitcnt lgkmcnt(2)
    buffer_store_dwordx4 v[48:51], v5, s[28:31], s33 offen sc1
    s_add_u32 s33, s33, 262144
    s_waitcnt lgkmcnt(1)
    buffer_store_dwordx4 v[52:55], v5, s[28:31], s33 offen sc1
    s_add_u32 s33, s33, 262144
    s_waitcnt lgkmcnt(0)
    buffer_store_dwordx4 v[56:59], v5, s[28:31], s33 offen sc1
    s_add_u32 s33, s33, 262144
    s_cmp_lg_u32 s32, 7
    s_cbranch_scc1 k_prep_icd_41
    v_mov_b32 v22, 0
k_prep_icl_42:
    global_load_dword v23, v22, s[24:25] sc1
    s_waitcnt vmcnt(0)
    v_readfirstlane_b32 s33, v23
    s_nop 3
    s_cmp_ge_u32 s33, 32
    s_cbranch_scc1 k_prep_icd_41
    s_sleep 12
    s_branch k_prep_icl_42
k_prep_icd_41:
    s_waitcnt vmcnt(0)
    s_barrier
    s_cmp_lg_u32 s32, 7
    s_cbranch_scc1 k_prep_np_43
    v_lshlrev_b32 v4, 9, v1
    s_lshl_b32 s33, s54, 2
    s_add_u32 s33, s33, 9240832
    v_mov_b32 v3, 1
    buffer_store_dword v3, v4, s[28:31], s33 offen sc1
    s_add_u32 s33, s33, 32768
    buffer_store_dword v3, v4, s[28:31], s33 offen sc1
    s_add_u32 s33, s33, 32768
    buffer_store_dword v3, v4, s[28:31], s33 offen sc1
    s_add_u32 s33, s33, 32768
    s_mov_b32 exec_hi, 0
    buffer_store_dword v3, v4, s[28:31], s33 offen sc1
    s_add_u32 s33, s33, 32768
    s_mov_b64 exec, -1
    s_waitcnt vmcnt(0)
k_prep_np_43:
k_end:
k_last:
    s_endpgm
.section .rodata,"a"
.p2align 6
.amdhsa_kernel recurrent_scan__ssm_conv_h3__glu_gated_reglu__prompt_kernel
  .amdhsa_next_free_vgpr 168
  .amdhsa_next_free_sgpr 102
  .amdhsa_accum_offset 168
  .amdhsa_group_segment_fixed_size 0
  .amdhsa_kernarg_size 104
  .amdhsa_user_sgpr_count 2
  .amdhsa_user_sgpr_kernarg_segment_ptr 1
  .amdhsa_system_sgpr_workgroup_id_x 1
.end_amdhsa_kernel
```
